```python
import torch

def _softmax(x, axis=-1):
    return torch.softmax(x, dim=axis)

def _gelu(x):
    return torch.nn.functional.gelu(x, approximate='tanh')

def _silu(x):
    return torch.nn.functional.silu(x)

def _sigmoid(x):
    return torch.sigmoid(x)

def _layernorm(x, axis=-1, eps=1e-05):
    m = x.mean(dim=axis, keepdim=True)
    v = x.var(dim=axis, keepdim=True, unbiased=False)
    return (x - m) / torch.sqrt(v + eps)

def _scatter_add(tgt, idx, src, axis=0):
    return tgt.clone().index_add_(axis, idx, src)

def _segment_sum(src, seg, n):
    out = torch.zeros((n,) + src.shape[1:], dtype=src.dtype)
    return out.index_add_(0, seg, src)

def _pad(x, pw):
    flat = tuple((v for pair in reversed(pw) for v in pair))
    return torch.nn.functional.pad(x, flat)
kernel_name = 'standalone__molecular_angular_painn__graph'

def setup_inputs():

    _w = lambda a: (lambda t: t.to(torch.bfloat16) if t.is_floating_point() else t)(torch.as_tensor(a))
    N, deg, D = (10000, 32, 128)
    n_rbf = max(0, 4)
    E = N * deg
    cutoff = 5.0
    freqs = (torch.arange(1, n_rbf + 1) * torch.pi / cutoff).to(float)
    return {'sv': _w((lambda *s: torch.randn(*s, dtype=torch.bfloat16) * 0.4)(N, 4, D) * 0.3), 'pos': _w((lambda *s: torch.randn(*s, dtype=torch.bfloat16) * 3.2)(N, 3) * 1.2), 'src': _w((lambda lo, hi, *s: torch.randint(lo, hi, s))(0, N, E).to(torch.int64)), 'dst': _w((lambda lo, hi, *s: torch.randint(lo, hi, s))(0, N, E).to(torch.int64)), 'freqs': _w(freqs), 'w_phi1': _w((lambda *s: torch.randn(*s, dtype=torch.bfloat16) * 3.2)(D, D) / D ** 0.5), 'w_phi2': _w((lambda *s: torch.randn(*s, dtype=torch.bfloat16) * 3.2)(D, 3 * D) / D ** 0.5), 'w_rbf': _w((lambda *s: torch.randn(*s, dtype=torch.bfloat16) * 3.2)(n_rbf, 3 * D) / n_rbf ** 0.5)}

def reference(sv, pos, src, dst, freqs, w_phi1, w_phi2, w_rbf):
    N, _, D = sv.shape
    E = src.shape[0]
    PI, cutoff = (3.141592653589793, 5.0)
    s, v = (sv[:, 0, :].clone(), sv[:, 1:, :].clone())
    r_vec = pos[src] - pos[dst]
    d = torch.sqrt((r_vec * r_vec).sum(-1) + 1e-08)
    r_hat = r_vec / d[:, None]
    rbf = torch.sin(d[:, None] * freqs[None, :]) / d[:, None]
    fcut = 0.5 * (torch.cos(PI * d / cutoff) + 1.0)
    fcut = torch.where(d < cutoff, fcut, 0.0 * d)
    Wf = rbf @ w_rbf * fcut[:, None]
    phi = (_silu(s @ w_phi1) @ w_phi2)[src]
    m = phi * Wf
    m_s, m_vv, m_vr = (m[:, :D].clone(), m[:, D:2 * D].clone(), m[:, 2 * D:].clone())
    ds = _segment_sum(m_s, dst, N)
    dv_e = m_vv[:, None, :] * v[src] + m_vr[:, None, :] * r_hat[:, :, None]
    dv = _segment_sum(dv_e.reshape(E, 3 * D), dst, N).reshape(N, 3, D)
    return sv + torch.concatenate([ds[:, None, :], dv], axis=1)
```

```asm
; @launch kernel=painn_k1_kernel grid=(256,1,1) block=(1024,1,1) lds=149536
; @launch kernel=painn_k2_kernel grid=(256,1,1) block=(768,1,1) lds=87552
.amdgcn_target "amdgcn-amd-amdhsa--gfx950"
.text
.globl painn_k1_kernel
.p2align 8
.type painn_k1_kernel,@function
painn_k1_kernel:
    s_cmp_ge_u32 s2, 256
    s_cbranch_scc1 K1_END
    s_load_dwordx8 s[4:11], s[0:1], 0
    s_load_dwordx8 s[12:19], s[0:1], 32
    s_load_dwordx2 s[20:21], s[0:1], 80
    v_and_b32 v1, 63, v0
    v_lshrrev_b32 v2, 6, v0
    s_nop 0
    v_readfirstlane_b32 s3, v2
    v_and_b32 v3, 15, v1
    v_lshrrev_b32 v4, 4, v1
    s_lshr_b32 s42, s2, 3
    s_and_b32 s43, s42, 3
    s_cmp_ge_u32 s2, 210
    s_cbranch_scc1 K1_PF
    s_cmp_ge_u32 s2, 157
    s_cbranch_scc1 K1_EDGE
    s_mov_b32 s40, 0x05040100
    s_mov_b32 s41, 0x07060302
    v_lshlrev_b32 v5, 4, v1
    v_mov_b32 v10, 149504
    v_mov_b32 v12, 0
    v_mov_b32 v13, 0
    v_mov_b32 v14, 0
    v_mov_b32 v15, 0
    ds_write_b128 v10, v[12:15]
    ds_write_b64 v10, v[12:13] offset:16
    v_mov_b32 v11, 1
    v_lshlrev_b32 v126, 4, v0
    v_add_u32 v127, 33792, v126
    s_mul_i32 s56, s2, 49152
    v_add_u32 v6, 0, v4
    v_xor_b32 v6, v6, v3
    v_lshlrev_b32 v6, 4, v6
    v_lshl_add_u32 v6, v3, 8, v6
    v_add_u32 v112, 133120, v6
    v_add_u32 v6, 4, v4
    v_xor_b32 v6, v6, v3
    v_lshlrev_b32 v6, 4, v6
    v_lshl_add_u32 v6, v3, 8, v6
    v_add_u32 v113, 133120, v6
    v_add_u32 v6, 8, v4
    v_xor_b32 v6, v6, v3
    v_lshlrev_b32 v6, 4, v6
    v_lshl_add_u32 v6, v3, 8, v6
    v_add_u32 v114, 133120, v6
    v_add_u32 v6, 12, v4
    v_xor_b32 v6, v6, v3
    v_lshlrev_b32 v6, 4, v6
    v_lshl_add_u32 v6, v3, 8, v6
    v_add_u32 v115, 133120, v6
    s_lshl_b32 s47, s43, 1
    s_add_u32 s47, s47, s3
    s_and_b32 s47, s47, 7
    s_cmp_lt_u32 s3, 8
    s_cbranch_scc1 K1_G1
    s_mul_i32 s50, s47, 12288
    s_mul_i32 s52, s47, 12416
    s_and_b32 s23, s3, 3
    s_mul_i32 s23, s23, 3
    s_bfe_u32 s44, s3, 0x10002
    s_add_u32 s45, s23, 1
    s_lshl_b32 s48, s44, 1
    s_add_u32 s23, s23, s48
    v_mov_b32 v126, v10
    v_mov_b32 v127, 1
    s_lshl_b32 s48, s44, 13
    s_waitcnt lgkmcnt(0)
    s_barrier
    s_mov_b32 s32, s16
    s_mov_b32 s33, s17
    s_mov_b32 s34, 0x18000
    s_mov_b32 s35, 0x20000
    s_add_u32 s49, s43, 0
    s_and_b32 s49, s49, 3
    s_mul_i32 s51, s49, 3072
    s_lshr_b32 s49, s49, 1
    s_lshl_b32 s49, s49, 6
    s_add_u32 s49, s49, s51
    s_add_u32 s49, s49, s52
    s_add_u32 m0, s49, 33792
    s_add_u32 s51, s51, s50
    buffer_load_dwordx4 v5, s[32:35], s51 offen offset:0 lds
    buffer_load_dwordx4 v5, s[32:35], s51 offen offset:1024 lds
    buffer_load_dwordx4 v5, s[32:35], s51 offen offset:2048 lds
    s_add_u32 s49, s43, 1
    s_and_b32 s49, s49, 3
    s_mul_i32 s51, s49, 3072
    s_lshr_b32 s49, s49, 1
    s_lshl_b32 s49, s49, 6
    s_add_u32 s49, s49, s51
    s_add_u32 s49, s49, s52
    s_add_u32 m0, s49, 33792
    s_add_u32 s51, s51, s50
    buffer_load_dwordx4 v5, s[32:35], s51 offen offset:0 lds
    buffer_load_dwordx4 v5, s[32:35], s51 offen offset:1024 lds
    buffer_load_dwordx4 v5, s[32:35], s51 offen offset:2048 lds
    s_add_u32 s49, s43, 2
    s_and_b32 s49, s49, 3
    s_mul_i32 s51, s49, 3072
    s_lshr_b32 s49, s49, 1
    s_lshl_b32 s49, s49, 6
    s_add_u32 s49, s49, s51
    s_add_u32 s49, s49, s52
    s_add_u32 m0, s49, 33792
    s_add_u32 s51, s51, s50
    buffer_load_dwordx4 v5, s[32:35], s51 offen offset:0 lds
    buffer_load_dwordx4 v5, s[32:35], s51 offen offset:1024 lds
    buffer_load_dwordx4 v5, s[32:35], s51 offen offset:2048 lds
    s_add_u32 s49, s43, 3
    s_and_b32 s49, s49, 3
    s_mul_i32 s51, s49, 3072
    s_lshr_b32 s49, s49, 1
    s_lshl_b32 s49, s49, 6
    s_add_u32 s49, s49, s51
    s_add_u32 s49, s49, s52
    s_add_u32 m0, s49, 33792
    s_add_u32 s51, s51, s50
    buffer_load_dwordx4 v5, s[32:35], s51 offen offset:0 lds
    buffer_load_dwordx4 v5, s[32:35], s51 offen offset:1024 lds
    buffer_load_dwordx4 v5, s[32:35], s51 offen offset:2048 lds
    v_mul_u32_u24 v6, 6208, v4
    v_lshl_add_u32 v6, v3, 2, v6
    v_mul_u32_u24 v7, 3072, v4
    v_lshl_add_u32 v7, v3, 2, v7
    s_lshl_b32 s49, s23, 6
    s_add_u32 s49, s49, 33792
    v_add_u32 v116, s49, v6
    v_add_u32 v117, 49664, v116
    s_lshr_b32 s49, s23, 2
    s_lshl_b32 s49, s49, 7
    s_bfe_u32 s68, s23, 0x10001
    s_mul_i32 s68, s68, 384
    s_add_u32 s49, s49, s68
    s_and_b32 s68, s23, 1
    s_lshl_b32 s68, s68, 6
    s_add_u32 s49, s49, s68
    s_add_u32 s49, s49, 33792
    v_add_u32 v120, s49, v7
    s_lshl_b32 s49, s45, 6
    s_add_u32 s49, s49, 33792
    v_add_u32 v118, s49, v6
    v_add_u32 v119, 49664, v118
    s_lshr_b32 s49, s45, 2
    s_lshl_b32 s49, s49, 7
    s_bfe_u32 s68, s45, 0x10001
    s_mul_i32 s68, s68, 384
    s_add_u32 s49, s49, s68
    s_and_b32 s68, s45, 1
    s_lshl_b32 s68, s68, 6
    s_add_u32 s49, s49, s68
    s_add_u32 s49, s49, 33792
    v_add_u32 v121, s49, v7
    s_mul_i32 s49, s44, 24576
    v_add_u32 v121, s49, v121
    v_add_u32 v122, s48, v112
    v_add_u32 v123, s48, v113
    v_add_u32 v124, s48, v114
    v_add_u32 v125, s48, v115
    s_waitcnt vmcnt(0)
    s_mov_b64 exec, 1
    ds_add_u32 v10, v11 offset:4
    s_mov_b64 exec, -1
K1_SP_W2:
    ds_read_b32 v13, v10 offset:4
    s_waitcnt lgkmcnt(0)
    v_readfirstlane_b32 s46, v13
    s_nop 0
    s_cmp_lt_u32 s46, 8
    s_nop 1
    s_cbranch_scc0 K1_SX_W2
    s_sleep 1
    s_branch K1_SP_W2
K1_SX_W2:
    ds_read2st64_b32 v[16:17], v116 offset0:0 offset1:3
    ds_read2st64_b32 v[18:19], v116 offset0:6 offset1:9
    ds_read2st64_b32 v[20:21], v116 offset0:12 offset1:15
    ds_read2st64_b32 v[22:23], v116 offset0:18 offset1:21
    ds_read2st64_b32 v[24:25], v116 offset0:97 offset1:100
    ds_read2st64_b32 v[26:27], v116 offset0:103 offset1:106
    ds_read2st64_b32 v[28:29], v116 offset0:109 offset1:112
    ds_read2st64_b32 v[30:31], v116 offset0:115 offset1:118
    ds_read2st64_b32 v[32:33], v117 offset0:0 offset1:3
    ds_read2st64_b32 v[34:35], v117 offset0:6 offset1:9
    ds_read2st64_b32 v[36:37], v117 offset0:12 offset1:15
    ds_read2st64_b32 v[38:39], v117 offset0:18 offset1:21
    ds_read2st64_b32 v[40:41], v117 offset0:97 offset1:100
    ds_read2st64_b32 v[42:43], v117 offset0:103 offset1:106
    ds_read2st64_b32 v[44:45], v117 offset0:109 offset1:112
    ds_read2st64_b32 v[46:47], v117 offset0:115 offset1:118
    s_waitcnt lgkmcnt(12)
    v_perm_b32 v48, v17, v16, s40
    v_perm_b32 v52, v17, v16, s41
    v_perm_b32 v49, v19, v18, s40
    v_perm_b32 v53, v19, v18, s41
    v_perm_b32 v50, v21, v20, s40
    v_perm_b32 v54, v21, v20, s41
    v_perm_b32 v51, v23, v22, s40
    v_perm_b32 v55, v23, v22, s41
    s_waitcnt lgkmcnt(8)
    v_perm_b32 v56, v25, v24, s40
    v_perm_b32 v60, v25, v24, s41
    v_perm_b32 v57, v27, v26, s40
    v_perm_b32 v61, v27, v26, s41
    v_perm_b32 v58, v29, v28, s40
    v_perm_b32 v62, v29, v28, s41
    v_perm_b32 v59, v31, v30, s40
    v_perm_b32 v63, v31, v30, s41
    s_waitcnt lgkmcnt(4)
    v_perm_b32 v64, v33, v32, s40
    v_perm_b32 v68, v33, v32, s41
    v_perm_b32 v65, v35, v34, s40
    v_perm_b32 v69, v35, v34, s41
    v_perm_b32 v66, v37, v36, s40
    v_perm_b32 v70, v37, v36, s41
    v_perm_b32 v67, v39, v38, s40
    v_perm_b32 v71, v39, v38, s41
    s_waitcnt lgkmcnt(0)
    v_perm_b32 v72, v41, v40, s40
    v_perm_b32 v76, v41, v40, s41
    v_perm_b32 v73, v43, v42, s40
    v_perm_b32 v77, v43, v42, s41
    v_perm_b32 v74, v45, v44, s40
    v_perm_b32 v78, v45, v44, s41
    v_perm_b32 v75, v47, v46, s40
    v_perm_b32 v79, v47, v46, s41
    ds_read2st64_b32 v[16:17], v118 offset0:0 offset1:3
    ds_read2st64_b32 v[18:19], v118 offset0:6 offset1:9
    ds_read2st64_b32 v[20:21], v118 offset0:12 offset1:15
    ds_read2st64_b32 v[22:23], v118 offset0:18 offset1:21
    ds_read2st64_b32 v[24:25], v118 offset0:97 offset1:100
    ds_read2st64_b32 v[26:27], v118 offset0:103 offset1:106
    ds_read2st64_b32 v[28:29], v118 offset0:109 offset1:112
    ds_read2st64_b32 v[30:31], v118 offset0:115 offset1:118
    ds_read2st64_b32 v[32:33], v119 offset0:0 offset1:3
    ds_read2st64_b32 v[34:35], v119 offset0:6 offset1:9
    ds_read2st64_b32 v[36:37], v119 offset0:12 offset1:15
    ds_read2st64_b32 v[38:39], v119 offset0:18 offset1:21
    ds_read2st64_b32 v[40:41], v119 offset0:97 offset1:100
    ds_read2st64_b32 v[42:43], v119 offset0:103 offset1:106
    ds_read2st64_b32 v[44:45], v119 offset0:109 offset1:112
    ds_read2st64_b32 v[46:47], v119 offset0:115 offset1:118
    s_waitcnt lgkmcnt(12)
    v_perm_b32 v80, v17, v16, s40
    v_perm_b32 v84, v17, v16, s41
    v_perm_b32 v81, v19, v18, s40
    v_perm_b32 v85, v19, v18, s41
    v_perm_b32 v82, v21, v20, s40
    v_perm_b32 v86, v21, v20, s41
    v_perm_b32 v83, v23, v22, s40
    v_perm_b32 v87, v23, v22, s41
    s_waitcnt lgkmcnt(8)
    v_perm_b32 v88, v25, v24, s40
    v_perm_b32 v92, v25, v24, s41
    v_perm_b32 v89, v27, v26, s40
    v_perm_b32 v93, v27, v26, s41
    v_perm_b32 v90, v29, v28, s40
    v_perm_b32 v94, v29, v28, s41
    v_perm_b32 v91, v31, v30, s40
    v_perm_b32 v95, v31, v30, s41
    s_waitcnt lgkmcnt(4)
    v_perm_b32 v96, v33, v32, s40
    v_perm_b32 v100, v33, v32, s41
    v_perm_b32 v97, v35, v34, s40
    v_perm_b32 v101, v35, v34, s41
    v_perm_b32 v98, v37, v36, s40
    v_perm_b32 v102, v37, v36, s41
    v_perm_b32 v99, v39, v38, s40
    v_perm_b32 v103, v39, v38, s41
    s_waitcnt lgkmcnt(0)
    v_perm_b32 v104, v41, v40, s40
    v_perm_b32 v108, v41, v40, s41
    v_perm_b32 v105, v43, v42, s40
    v_perm_b32 v109, v43, v42, s41
    v_perm_b32 v106, v45, v44, s40
    v_perm_b32 v110, v45, v44, s41
    v_perm_b32 v107, v47, v46, s40
    v_perm_b32 v111, v47, v46, s41
    s_barrier
    s_cmp_lg_u32 s44, 0
    s_cbranch_scc1 K1_G2B
    ds_read_b128 v[16:19], v112 offset:0
    ds_read_b128 v[20:23], v113 offset:0
    ds_read_b128 v[24:27], v114 offset:0
    ds_read_b128 v[28:31], v115 offset:0
    ds_read_b128 v[32:35], v112 offset:4096
    ds_read_b128 v[36:39], v113 offset:4096
    ds_read_b128 v[40:43], v114 offset:4096
    ds_read_b128 v[44:47], v115 offset:4096
    s_waitcnt lgkmcnt(4)
    v_mfma_f32_16x16x32_bf16 v[8:11], v[16:19], v[48:51], 0
    v_mfma_f32_16x16x32_bf16 v[12:15], v[16:19], v[52:55], 0
    v_mfma_f32_16x16x32_bf16 v[8:11], v[20:23], v[56:59], v[8:11]
    v_mfma_f32_16x16x32_bf16 v[12:15], v[20:23], v[60:63], v[12:15]
    v_mfma_f32_16x16x32_bf16 v[8:11], v[24:27], v[64:67], v[8:11]
    v_mfma_f32_16x16x32_bf16 v[12:15], v[24:27], v[68:71], v[12:15]
    v_mfma_f32_16x16x32_bf16 v[8:11], v[28:31], v[72:75], v[8:11]
    v_mfma_f32_16x16x32_bf16 v[12:15], v[28:31], v[76:79], v[12:15]
    ds_read_b128 v[16:19], v122 offset:0
    ds_read_b128 v[20:23], v123 offset:0
    ds_read_b128 v[24:27], v124 offset:0
    ds_read_b128 v[28:31], v125 offset:0
    s_waitcnt lgkmcnt(4)
    v_mfma_f32_16x16x32_bf16 v[0:3], v[32:35], v[48:51], 0
    v_mfma_f32_16x16x32_bf16 v[4:7], v[32:35], v[52:55], 0
    v_mfma_f32_16x16x32_bf16 v[0:3], v[36:39], v[56:59], v[0:3]
    v_mfma_f32_16x16x32_bf16 v[4:7], v[36:39], v[60:63], v[4:7]
    v_mfma_f32_16x16x32_bf16 v[0:3], v[40:43], v[64:67], v[0:3]
    v_cvt_pk_bf16_f32 v116, v8, v12
    ds_write_b32 v120, v116 offset:0
    v_mfma_f32_16x16x32_bf16 v[4:7], v[40:43], v[68:71], v[4:7]
    v_cvt_pk_bf16_f32 v117, v9, v13
    ds_write_b32 v120, v117 offset:768
    v_mfma_f32_16x16x32_bf16 v[0:3], v[44:47], v[72:75], v[0:3]
    v_cvt_pk_bf16_f32 v118, v10, v14
    ds_write_b32 v120, v118 offset:1536
    v_mfma_f32_16x16x32_bf16 v[4:7], v[44:47], v[76:79], v[4:7]
    v_cvt_pk_bf16_f32 v119, v11, v15
    ds_write_b32 v120, v119 offset:2304
    ds_read_b128 v[32:35], v122 offset:4096
    ds_read_b128 v[36:39], v123 offset:4096
    ds_read_b128 v[40:43], v124 offset:4096
    ds_read_b128 v[44:47], v125 offset:4096
    s_waitcnt lgkmcnt(8)
    v_mfma_f32_16x16x32_bf16 v[8:11], v[16:19], v[80:83], 0
    v_mfma_f32_16x16x32_bf16 v[12:15], v[16:19], v[84:87], 0
    v_mfma_f32_16x16x32_bf16 v[8:11], v[20:23], v[88:91], v[8:11]
    v_mfma_f32_16x16x32_bf16 v[12:15], v[20:23], v[92:95], v[12:15]
    v_mfma_f32_16x16x32_bf16 v[8:11], v[24:27], v[96:99], v[8:11]
    v_cvt_pk_bf16_f32 v116, v0, v4
    ds_write_b32 v120, v116 offset:12288
    v_mfma_f32_16x16x32_bf16 v[12:15], v[24:27], v[100:103], v[12:15]
    v_cvt_pk_bf16_f32 v117, v1, v5
    ds_write_b32 v120, v117 offset:13056
    v_mfma_f32_16x16x32_bf16 v[8:11], v[28:31], v[104:107], v[8:11]
    v_cvt_pk_bf16_f32 v118, v2, v6
    ds_write_b32 v120, v118 offset:13824
    v_mfma_f32_16x16x32_bf16 v[12:15], v[28:31], v[108:111], v[12:15]
    v_cvt_pk_bf16_f32 v119, v3, v7
    ds_write_b32 v120, v119 offset:14592
    ds_read_b128 v[16:19], v112 offset:8192
    ds_read_b128 v[20:23], v113 offset:8192
    ds_read_b128 v[24:27], v114 offset:8192
    ds_read_b128 v[28:31], v115 offset:8192
    s_waitcnt lgkmcnt(8)
    v_mfma_f32_16x16x32_bf16 v[0:3], v[32:35], v[80:83], 0
    v_mfma_f32_16x16x32_bf16 v[4:7], v[32:35], v[84:87], 0
    v_mfma_f32_16x16x32_bf16 v[0:3], v[36:39], v[88:91], v[0:3]
    v_mfma_f32_16x16x32_bf16 v[4:7], v[36:39], v[92:95], v[4:7]
    v_mfma_f32_16x16x32_bf16 v[0:3], v[40:43], v[96:99], v[0:3]
    v_cvt_pk_bf16_f32 v116, v8, v12
    ds_write_b32 v121, v116 offset:0
    v_mfma_f32_16x16x32_bf16 v[4:7], v[40:43], v[100:103], v[4:7]
    v_cvt_pk_bf16_f32 v117, v9, v13
    ds_write_b32 v121, v117 offset:768
    v_mfma_f32_16x16x32_bf16 v[0:3], v[44:47], v[104:107], v[0:3]
    v_cvt_pk_bf16_f32 v118, v10, v14
    ds_write_b32 v121, v118 offset:1536
    v_mfma_f32_16x16x32_bf16 v[4:7], v[44:47], v[108:111], v[4:7]
    v_cvt_pk_bf16_f32 v119, v11, v15
    ds_write_b32 v121, v119 offset:2304
    ds_read_b128 v[32:35], v112 offset:12288
    ds_read_b128 v[36:39], v113 offset:12288
    ds_read_b128 v[40:43], v114 offset:12288
    ds_read_b128 v[44:47], v115 offset:12288
    s_waitcnt lgkmcnt(8)
    v_mfma_f32_16x16x32_bf16 v[8:11], v[16:19], v[48:51], 0
    v_mfma_f32_16x16x32_bf16 v[12:15], v[16:19], v[52:55], 0
    v_mfma_f32_16x16x32_bf16 v[8:11], v[20:23], v[56:59], v[8:11]
    v_mfma_f32_16x16x32_bf16 v[12:15], v[20:23], v[60:63], v[12:15]
    v_mfma_f32_16x16x32_bf16 v[8:11], v[24:27], v[64:67], v[8:11]
    v_cvt_pk_bf16_f32 v116, v0, v4
    ds_write_b32 v121, v116 offset:12288
    v_mfma_f32_16x16x32_bf16 v[12:15], v[24:27], v[68:71], v[12:15]
    v_cvt_pk_bf16_f32 v117, v1, v5
    ds_write_b32 v121, v117 offset:13056
    v_mfma_f32_16x16x32_bf16 v[8:11], v[28:31], v[72:75], v[8:11]
    v_cvt_pk_bf16_f32 v118, v2, v6
    ds_write_b32 v121, v118 offset:13824
    v_mfma_f32_16x16x32_bf16 v[12:15], v[28:31], v[76:79], v[12:15]
    v_cvt_pk_bf16_f32 v119, v3, v7
    ds_write_b32 v121, v119 offset:14592
    s_mov_b64 exec, 1
    ds_add_u32 v126, v127 offset:16
    s_mov_b64 exec, -1
    s_waitcnt lgkmcnt(5)
    v_mfma_f32_16x16x32_bf16 v[0:3], v[32:35], v[48:51], 0
    v_mfma_f32_16x16x32_bf16 v[4:7], v[32:35], v[52:55], 0
    v_mfma_f32_16x16x32_bf16 v[0:3], v[36:39], v[56:59], v[0:3]
    v_mfma_f32_16x16x32_bf16 v[4:7], v[36:39], v[60:63], v[4:7]
    v_mfma_f32_16x16x32_bf16 v[0:3], v[40:43], v[64:67], v[0:3]
    v_cvt_pk_bf16_f32 v116, v8, v12
    ds_write_b32 v120, v116 offset:24576
    v_mfma_f32_16x16x32_bf16 v[4:7], v[40:43], v[68:71], v[4:7]
    v_cvt_pk_bf16_f32 v117, v9, v13
    ds_write_b32 v120, v117 offset:25344
    v_mfma_f32_16x16x32_bf16 v[0:3], v[44:47], v[72:75], v[0:3]
    v_cvt_pk_bf16_f32 v118, v10, v14
    ds_write_b32 v120, v118 offset:26112
    v_mfma_f32_16x16x32_bf16 v[4:7], v[44:47], v[76:79], v[4:7]
    v_cvt_pk_bf16_f32 v119, v11, v15
    ds_write_b32 v120, v119 offset:26880
    s_nop 5
    v_cvt_pk_bf16_f32 v116, v0, v4
    ds_write_b32 v120, v116 offset:36864
    v_cvt_pk_bf16_f32 v117, v1, v5
    ds_write_b32 v120, v117 offset:37632
    v_cvt_pk_bf16_f32 v118, v2, v6
    ds_write_b32 v120, v118 offset:38400
    v_cvt_pk_bf16_f32 v119, v3, v7
    ds_write_b32 v120, v119 offset:39168
    s_mov_b64 exec, 1
    ds_add_u32 v126, v127 offset:20
    s_mov_b64 exec, -1
    s_endpgm
K1_G2B:
    ds_read_b128 v[16:19], v112 offset:0
    ds_read_b128 v[20:23], v113 offset:0
    ds_read_b128 v[24:27], v114 offset:0
    ds_read_b128 v[28:31], v115 offset:0
    ds_read_b128 v[32:35], v112 offset:4096
    ds_read_b128 v[36:39], v113 offset:4096
    ds_read_b128 v[40:43], v114 offset:4096
    ds_read_b128 v[44:47], v115 offset:4096
    s_waitcnt lgkmcnt(4)
    v_mfma_f32_16x16x32_bf16 v[8:11], v[16:19], v[48:51], 0
    v_mfma_f32_16x16x32_bf16 v[12:15], v[16:19], v[52:55], 0
    v_mfma_f32_16x16x32_bf16 v[8:11], v[20:23], v[56:59], v[8:11]
    v_mfma_f32_16x16x32_bf16 v[12:15], v[20:23], v[60:63], v[12:15]
    v_mfma_f32_16x16x32_bf16 v[8:11], v[24:27], v[64:67], v[8:11]
    v_mfma_f32_16x16x32_bf16 v[12:15], v[24:27], v[68:71], v[12:15]
    v_mfma_f32_16x16x32_bf16 v[8:11], v[28:31], v[72:75], v[8:11]
    v_mfma_f32_16x16x32_bf16 v[12:15], v[28:31], v[76:79], v[12:15]
    ds_read_b128 v[16:19], v112 offset:8192
    ds_read_b128 v[20:23], v113 offset:8192
    ds_read_b128 v[24:27], v114 offset:8192
    ds_read_b128 v[28:31], v115 offset:8192
    s_waitcnt lgkmcnt(4)
    v_mfma_f32_16x16x32_bf16 v[0:3], v[32:35], v[48:51], 0
    v_mfma_f32_16x16x32_bf16 v[4:7], v[32:35], v[52:55], 0
    v_mfma_f32_16x16x32_bf16 v[0:3], v[36:39], v[56:59], v[0:3]
    v_mfma_f32_16x16x32_bf16 v[4:7], v[36:39], v[60:63], v[4:7]
    v_mfma_f32_16x16x32_bf16 v[0:3], v[40:43], v[64:67], v[0:3]
    v_cvt_pk_bf16_f32 v116, v8, v12
    ds_write_b32 v120, v116 offset:0
    v_mfma_f32_16x16x32_bf16 v[4:7], v[40:43], v[68:71], v[4:7]
    v_cvt_pk_bf16_f32 v117, v9, v13
    ds_write_b32 v120, v117 offset:768
    v_mfma_f32_16x16x32_bf16 v[0:3], v[44:47], v[72:75], v[0:3]
    v_cvt_pk_bf16_f32 v118, v10, v14
    ds_write_b32 v120, v118 offset:1536
    v_mfma_f32_16x16x32_bf16 v[4:7], v[44:47], v[76:79], v[4:7]
    v_cvt_pk_bf16_f32 v119, v11, v15
    ds_write_b32 v120, v119 offset:2304
    ds_read_b128 v[32:35], v112 offset:12288
    ds_read_b128 v[36:39], v113 offset:12288
    ds_read_b128 v[40:43], v114 offset:12288
    ds_read_b128 v[44:47], v115 offset:12288
    s_waitcnt lgkmcnt(8)
    v_mfma_f32_16x16x32_bf16 v[8:11], v[16:19], v[48:51], 0
    v_mfma_f32_16x16x32_bf16 v[12:15], v[16:19], v[52:55], 0
    v_mfma_f32_16x16x32_bf16 v[8:11], v[20:23], v[56:59], v[8:11]
    v_mfma_f32_16x16x32_bf16 v[12:15], v[20:23], v[60:63], v[12:15]
    v_mfma_f32_16x16x32_bf16 v[8:11], v[24:27], v[64:67], v[8:11]
    v_cvt_pk_bf16_f32 v116, v0, v4
    ds_write_b32 v120, v116 offset:12288
    v_mfma_f32_16x16x32_bf16 v[12:15], v[24:27], v[68:71], v[12:15]
    v_cvt_pk_bf16_f32 v117, v1, v5
    ds_write_b32 v120, v117 offset:13056
    v_mfma_f32_16x16x32_bf16 v[8:11], v[28:31], v[72:75], v[8:11]
    v_cvt_pk_bf16_f32 v118, v2, v6
    ds_write_b32 v120, v118 offset:13824
    v_mfma_f32_16x16x32_bf16 v[12:15], v[28:31], v[76:79], v[12:15]
    v_cvt_pk_bf16_f32 v119, v3, v7
    ds_write_b32 v120, v119 offset:14592
    s_mov_b64 exec, 1
    ds_add_u32 v126, v127 offset:16
    s_mov_b64 exec, -1
    ds_read_b128 v[16:19], v122 offset:0
    ds_read_b128 v[20:23], v123 offset:0
    ds_read_b128 v[24:27], v124 offset:0
    ds_read_b128 v[28:31], v125 offset:0
    s_waitcnt lgkmcnt(9)
    v_mfma_f32_16x16x32_bf16 v[0:3], v[32:35], v[48:51], 0
    v_mfma_f32_16x16x32_bf16 v[4:7], v[32:35], v[52:55], 0
    v_mfma_f32_16x16x32_bf16 v[0:3], v[36:39], v[56:59], v[0:3]
    v_mfma_f32_16x16x32_bf16 v[4:7], v[36:39], v[60:63], v[4:7]
    v_mfma_f32_16x16x32_bf16 v[0:3], v[40:43], v[64:67], v[0:3]
    v_cvt_pk_bf16_f32 v116, v8, v12
    ds_write_b32 v120, v116 offset:24576
    v_mfma_f32_16x16x32_bf16 v[4:7], v[40:43], v[68:71], v[4:7]
    v_cvt_pk_bf16_f32 v117, v9, v13
    ds_write_b32 v120, v117 offset:25344
    v_mfma_f32_16x16x32_bf16 v[0:3], v[44:47], v[72:75], v[0:3]
    v_cvt_pk_bf16_f32 v118, v10, v14
    ds_write_b32 v120, v118 offset:26112
    v_mfma_f32_16x16x32_bf16 v[4:7], v[44:47], v[76:79], v[4:7]
    v_cvt_pk_bf16_f32 v119, v11, v15
    ds_write_b32 v120, v119 offset:26880
    ds_read_b128 v[32:35], v122 offset:4096
    ds_read_b128 v[36:39], v123 offset:4096
    ds_read_b128 v[40:43], v124 offset:4096
    ds_read_b128 v[44:47], v125 offset:4096
    s_waitcnt lgkmcnt(8)
    v_mfma_f32_16x16x32_bf16 v[8:11], v[16:19], v[80:83], 0
    v_mfma_f32_16x16x32_bf16 v[12:15], v[16:19], v[84:87], 0
    v_mfma_f32_16x16x32_bf16 v[8:11], v[20:23], v[88:91], v[8:11]
    v_mfma_f32_16x16x32_bf16 v[12:15], v[20:23], v[92:95], v[12:15]
    v_mfma_f32_16x16x32_bf16 v[8:11], v[24:27], v[96:99], v[8:11]
    v_cvt_pk_bf16_f32 v116, v0, v4
    ds_write_b32 v120, v116 offset:36864
    v_mfma_f32_16x16x32_bf16 v[12:15], v[24:27], v[100:103], v[12:15]
    v_cvt_pk_bf16_f32 v117, v1, v5
    ds_write_b32 v120, v117 offset:37632
    v_mfma_f32_16x16x32_bf16 v[8:11], v[28:31], v[104:107], v[8:11]
    v_cvt_pk_bf16_f32 v118, v2, v6
    ds_write_b32 v120, v118 offset:38400
    v_mfma_f32_16x16x32_bf16 v[12:15], v[28:31], v[108:111], v[12:15]
    v_cvt_pk_bf16_f32 v119, v3, v7
    ds_write_b32 v120, v119 offset:39168
    s_waitcnt lgkmcnt(4)
    v_mfma_f32_16x16x32_bf16 v[0:3], v[32:35], v[80:83], 0
    v_mfma_f32_16x16x32_bf16 v[4:7], v[32:35], v[84:87], 0
    v_mfma_f32_16x16x32_bf16 v[0:3], v[36:39], v[88:91], v[0:3]
    v_mfma_f32_16x16x32_bf16 v[4:7], v[36:39], v[92:95], v[4:7]
    v_mfma_f32_16x16x32_bf16 v[0:3], v[40:43], v[96:99], v[0:3]
    v_cvt_pk_bf16_f32 v116, v8, v12
    ds_write_b32 v121, v116 offset:0
    v_mfma_f32_16x16x32_bf16 v[4:7], v[40:43], v[100:103], v[4:7]
    v_cvt_pk_bf16_f32 v117, v9, v13
    ds_write_b32 v121, v117 offset:768
    v_mfma_f32_16x16x32_bf16 v[0:3], v[44:47], v[104:107], v[0:3]
    v_cvt_pk_bf16_f32 v118, v10, v14
    ds_write_b32 v121, v118 offset:1536
    v_mfma_f32_16x16x32_bf16 v[4:7], v[44:47], v[108:111], v[4:7]
    v_cvt_pk_bf16_f32 v119, v11, v15
    ds_write_b32 v121, v119 offset:2304
    s_nop 5
    v_cvt_pk_bf16_f32 v116, v0, v4
    ds_write_b32 v121, v116 offset:12288
    v_cvt_pk_bf16_f32 v117, v1, v5
    ds_write_b32 v121, v117 offset:13056
    v_cvt_pk_bf16_f32 v118, v2, v6
    ds_write_b32 v121, v118 offset:13824
    v_cvt_pk_bf16_f32 v119, v3, v7
    ds_write_b32 v121, v119 offset:14592
    s_mov_b64 exec, 1
    ds_add_u32 v126, v127 offset:20
    s_mov_b64 exec, -1
    s_endpgm
K1_G1:
    s_and_b32 s44, s3, 1
    s_lshl_b32 s44, s44, 3
    v_add_u32 v6, s44, v4
    v_xor_b32 v7, v6, v3
    v_lshlrev_b32 v7, 4, v7
    v_lshl_add_u32 v7, v4, 10, v7
    v_add_u32 v6, 4, v6
    v_xor_b32 v8, v6, v3
    v_lshlrev_b32 v8, 4, v8
    v_lshl_add_u32 v8, v4, 10, v8
    s_mul_i32 s45, s2, 65536
    s_lshl_b32 s46, s3, 13
    s_add_u32 s45, s45, s46
    s_add_u32 s48, s45, 4096
    s_lshl_b32 s46, s3, 11
    s_lshl_b32 s49, s47, 12
    s_mul_i32 s50, s47, 4224
    s_waitcnt lgkmcnt(0)
    s_mov_b32 s24, s4
    s_mov_b32 s25, s5
    s_mov_b32 s26, 0x9c4000
    s_mov_b32 s27, 0x20000
    s_mov_b32 s28, s14
    s_mov_b32 s29, s15
    s_mov_b32 s30, 0x8000
    s_mov_b32 s31, 0x20000
    s_add_u32 m0, s46, 133120
    s_nop 0
    buffer_load_dwordx4 v7, s[24:27], s45 offen lds
    s_add_u32 m0, s46, 134144
    s_nop 0
    buffer_load_dwordx4 v8, s[24:27], s48 offen lds
    s_add_u32 m0, s50, 0
    s_nop 0
    buffer_load_dwordx4 v5, s[28:31], s49 offen lds
    buffer_load_dwordx4 v5, s[28:31], s49 offen offset:1024 lds
    s_add_u32 m0, s50, 64
    s_nop 0
    buffer_load_dwordx4 v5, s[28:31], s49 offen offset:2048 lds
    buffer_load_dwordx4 v5, s[28:31], s49 offen offset:3072 lds
    s_barrier
    s_and_b32 s44, s3, 3
    s_lshr_b32 s45, s3, 2
    s_lshl_b32 s47, s45, 2
    v_add_u32 v9, s47, v10
    s_lshl_b32 s45, s45, 13
    v_mul_u32_u24 v5, 2112, v4
    v_lshl_add_u32 v5, v3, 2, v5
    s_lshl_b32 s46, s44, 6
    v_add_u32 v5, s46, v5
    v_lshrrev_b32 v6, 2, v3
    s_lshl_b32 s46, s44, 2
    v_add_u32 v6, s46, v6
    v_and_b32 v7, 3, v3
    v_lshlrev_b32 v7, 2, v7
    s_add_u32 s46, s45, 133120
    v_add_u32 v7, s46, v7
    v_lshl_add_u32 v8, v4, 2, 0
    v_xor_b32 v12, v6, v8
    v_lshl_add_u32 v12, v12, 4, v7
    v_lshl_add_u32 v116, v8, 8, v12
    v_lshl_add_u32 v8, v4, 2, 1
    v_xor_b32 v12, v6, v8
    v_lshl_add_u32 v12, v12, 4, v7
    v_lshl_add_u32 v117, v8, 8, v12
    v_lshl_add_u32 v8, v4, 2, 2
    v_xor_b32 v12, v6, v8
    v_lshl_add_u32 v12, v12, 4, v7
    v_lshl_add_u32 v118, v8, 8, v12
    v_lshl_add_u32 v8, v4, 2, 3
    v_xor_b32 v12, v6, v8
    v_lshl_add_u32 v12, v12, 4, v7
    v_lshl_add_u32 v119, v8, 8, v12
    v_add_u32 v121, s45, v112
    v_add_u32 v122, s45, v113
    v_add_u32 v123, s45, v114
    v_add_u32 v124, s45, v115
    s_waitcnt vmcnt(0)
    s_mov_b64 exec, 1
    ds_add_u32 v10, v11 offset:0
    s_mov_b64 exec, -1
K1_SP_A:
    ds_read_b32 v13, v10 offset:0
    s_waitcnt lgkmcnt(0)
    v_readfirstlane_b32 s46, v13
    s_nop 0
    s_cmp_lt_u32 s46, 8
    s_nop 1
    s_cbranch_scc0 K1_SX_A
    s_sleep 1
    s_branch K1_SP_A
K1_SX_A:
    ds_read2st64_b32 v[16:17], v5 offset0:0 offset1:1
    ds_read2st64_b32 v[18:19], v5 offset0:2 offset1:3
    ds_read2st64_b32 v[20:21], v5 offset0:4 offset1:5
    ds_read2st64_b32 v[22:23], v5 offset0:6 offset1:7
    ds_read2st64_b32 v[24:25], v5 offset0:33 offset1:34
    ds_read2st64_b32 v[26:27], v5 offset0:35 offset1:36
    ds_read2st64_b32 v[28:29], v5 offset0:37 offset1:38
    ds_read2st64_b32 v[30:31], v5 offset0:39 offset1:40
    ds_read2st64_b32 v[32:33], v5 offset0:66 offset1:67
    ds_read2st64_b32 v[34:35], v5 offset0:68 offset1:69
    ds_read2st64_b32 v[36:37], v5 offset0:70 offset1:71
    ds_read2st64_b32 v[38:39], v5 offset0:72 offset1:73
    ds_read2st64_b32 v[40:41], v5 offset0:99 offset1:100
    ds_read2st64_b32 v[42:43], v5 offset0:101 offset1:102
    ds_read2st64_b32 v[44:45], v5 offset0:103 offset1:104
    ds_read2st64_b32 v[46:47], v5 offset0:105 offset1:106
    ds_read_b128 v[80:83], v121 offset:0
    ds_read_b128 v[84:87], v122 offset:0
    ds_read_b128 v[88:91], v123 offset:0
    ds_read_b128 v[92:95], v124 offset:0
    ds_read_b128 v[96:99], v121 offset:4096
    ds_read_b128 v[100:103], v122 offset:4096
    ds_read_b128 v[104:107], v123 offset:4096
    ds_read_b128 v[108:111], v124 offset:4096
    s_waitcnt lgkmcnt(15)
    v_perm_b32 v48, v17, v16, s40
    v_perm_b32 v52, v17, v16, s41
    v_perm_b32 v49, v19, v18, s40
    v_perm_b32 v53, v19, v18, s41
    v_perm_b32 v50, v21, v20, s40
    v_perm_b32 v54, v21, v20, s41
    v_perm_b32 v51, v23, v22, s40
    v_perm_b32 v55, v23, v22, s41
    s_waitcnt lgkmcnt(15)
    v_perm_b32 v56, v25, v24, s40
    v_perm_b32 v60, v25, v24, s41
    v_perm_b32 v57, v27, v26, s40
    v_perm_b32 v61, v27, v26, s41
    v_perm_b32 v58, v29, v28, s40
    v_perm_b32 v62, v29, v28, s41
    v_perm_b32 v59, v31, v30, s40
    v_perm_b32 v63, v31, v30, s41
    s_waitcnt lgkmcnt(12)
    v_perm_b32 v64, v33, v32, s40
    v_perm_b32 v68, v33, v32, s41
    v_perm_b32 v65, v35, v34, s40
    v_perm_b32 v69, v35, v34, s41
    v_perm_b32 v66, v37, v36, s40
    v_perm_b32 v70, v37, v36, s41
    v_perm_b32 v67, v39, v38, s40
    v_perm_b32 v71, v39, v38, s41
    s_waitcnt lgkmcnt(8)
    v_perm_b32 v72, v41, v40, s40
    v_perm_b32 v76, v41, v40, s41
    v_perm_b32 v73, v43, v42, s40
    v_perm_b32 v77, v43, v42, s41
    v_perm_b32 v74, v45, v44, s40
    v_perm_b32 v78, v45, v44, s41
    v_perm_b32 v75, v47, v46, s40
    v_perm_b32 v79, v47, v46, s41
    s_waitcnt lgkmcnt(0)
    s_mov_b64 exec, 1
    ds_add_u32 v9, v11 offset:8
    s_mov_b64 exec, -1
    v_mfma_f32_16x16x32_bf16 v[16:19], v[80:83], v[48:51], 0
    v_mfma_f32_16x16x32_bf16 v[20:23], v[80:83], v[52:55], 0
    v_mfma_f32_16x16x32_bf16 v[16:19], v[84:87], v[56:59], v[16:19]
    v_mfma_f32_16x16x32_bf16 v[20:23], v[84:87], v[60:63], v[20:23]
    v_mfma_f32_16x16x32_bf16 v[16:19], v[88:91], v[64:67], v[16:19]
    v_mfma_f32_16x16x32_bf16 v[20:23], v[88:91], v[68:71], v[20:23]
    v_mfma_f32_16x16x32_bf16 v[16:19], v[92:95], v[72:75], v[16:19]
    v_mfma_f32_16x16x32_bf16 v[20:23], v[92:95], v[76:79], v[20:23]
    v_mfma_f32_16x16x32_bf16 v[24:27], v[96:99], v[48:51], 0
    v_mfma_f32_16x16x32_bf16 v[28:31], v[96:99], v[52:55], 0
    v_mfma_f32_16x16x32_bf16 v[24:27], v[100:103], v[56:59], v[24:27]
    v_mfma_f32_16x16x32_bf16 v[28:31], v[100:103], v[60:63], v[28:31]
    v_mfma_f32_16x16x32_bf16 v[24:27], v[104:107], v[64:67], v[24:27]
    v_mfma_f32_16x16x32_bf16 v[28:31], v[104:107], v[68:71], v[28:31]
    v_mfma_f32_16x16x32_bf16 v[24:27], v[108:111], v[72:75], v[24:27]
    v_mfma_f32_16x16x32_bf16 v[28:31], v[108:111], v[76:79], v[28:31]
K1_SP_F:
    ds_read_b32 v13, v9 offset:8
    s_waitcnt lgkmcnt(0)
    v_readfirstlane_b32 s46, v13
    s_nop 0
    s_cmp_lt_u32 s46, 4
    s_nop 1
    s_cbranch_scc0 K1_SX_F
    s_sleep 1
    s_branch K1_SP_F
K1_SX_F:
    v_cvt_pk_bf16_f32 v32, v16, v20
    v_cvt_pk_bf16_f32 v36, v17, v21
    v_lshlrev_b32 v16, 16, v32
    v_lshlrev_b32 v17, 16, v36
    v_and_b32 v20, 0xffff0000, v32
    v_and_b32 v21, 0xffff0000, v36
    v_mul_f32 v33, 0xbfb8aa3b, v16
    v_mul_f32 v37, 0xbfb8aa3b, v17
    v_mul_f32 v34, 0xbfb8aa3b, v20
    v_mul_f32 v38, 0xbfb8aa3b, v21
    v_exp_f32 v33, v33
    v_exp_f32 v37, v37
    v_exp_f32 v34, v34
    v_exp_f32 v38, v38
    v_add_f32 v33, 1.0, v33
    v_add_f32 v37, 1.0, v37
    v_add_f32 v34, 1.0, v34
    v_add_f32 v38, 1.0, v38
    v_rcp_f32 v33, v33
    v_rcp_f32 v37, v37
    v_rcp_f32 v34, v34
    v_rcp_f32 v38, v38
    v_mul_f32 v16, v16, v33
    v_mul_f32 v17, v17, v37
    v_mul_f32 v20, v20, v34
    v_mul_f32 v21, v21, v38
    v_cvt_pk_bf16_f32 v35, v16, v20
    v_cvt_pk_bf16_f32 v39, v17, v21
    ds_write_b32 v116, v35 offset:0
    ds_write_b32 v117, v39 offset:0
    v_cvt_pk_bf16_f32 v40, v18, v22
    v_cvt_pk_bf16_f32 v44, v19, v23
    v_lshlrev_b32 v18, 16, v40
    v_lshlrev_b32 v19, 16, v44
    v_and_b32 v22, 0xffff0000, v40
    v_and_b32 v23, 0xffff0000, v44
    v_mul_f32 v41, 0xbfb8aa3b, v18
    v_mul_f32 v45, 0xbfb8aa3b, v19
    v_mul_f32 v42, 0xbfb8aa3b, v22
    v_mul_f32 v46, 0xbfb8aa3b, v23
    v_exp_f32 v41, v41
    v_exp_f32 v45, v45
    v_exp_f32 v42, v42
    v_exp_f32 v46, v46
    v_add_f32 v41, 1.0, v41
    v_add_f32 v45, 1.0, v45
    v_add_f32 v42, 1.0, v42
    v_add_f32 v46, 1.0, v46
    v_rcp_f32 v41, v41
    v_rcp_f32 v45, v45
    v_rcp_f32 v42, v42
    v_rcp_f32 v46, v46
    v_mul_f32 v18, v18, v41
    v_mul_f32 v19, v19, v45
    v_mul_f32 v22, v22, v42
    v_mul_f32 v23, v23, v46
    v_cvt_pk_bf16_f32 v43, v18, v22
    v_cvt_pk_bf16_f32 v47, v19, v23
    ds_write_b32 v118, v43 offset:0
    ds_write_b32 v119, v47 offset:0
    v_cvt_pk_bf16_f32 v32, v24, v28
    v_cvt_pk_bf16_f32 v36, v25, v29
    v_lshlrev_b32 v24, 16, v32
    v_lshlrev_b32 v25, 16, v36
    v_and_b32 v28, 0xffff0000, v32
    v_and_b32 v29, 0xffff0000, v36
    v_mul_f32 v33, 0xbfb8aa3b, v24
    v_mul_f32 v37, 0xbfb8aa3b, v25
    v_mul_f32 v34, 0xbfb8aa3b, v28
    v_mul_f32 v38, 0xbfb8aa3b, v29
    v_exp_f32 v33, v33
    v_exp_f32 v37, v37
    v_exp_f32 v34, v34
    v_exp_f32 v38, v38
    v_add_f32 v33, 1.0, v33
    v_add_f32 v37, 1.0, v37
    v_add_f32 v34, 1.0, v34
    v_add_f32 v38, 1.0, v38
    v_rcp_f32 v33, v33
    v_rcp_f32 v37, v37
    v_rcp_f32 v34, v34
    v_rcp_f32 v38, v38
    v_mul_f32 v24, v24, v33
    v_mul_f32 v25, v25, v37
    v_mul_f32 v28, v28, v34
    v_mul_f32 v29, v29, v38
    v_cvt_pk_bf16_f32 v35, v24, v28
    v_cvt_pk_bf16_f32 v39, v25, v29
    ds_write_b32 v116, v35 offset:4096
    ds_write_b32 v117, v39 offset:4096
    v_cvt_pk_bf16_f32 v40, v26, v30
    v_cvt_pk_bf16_f32 v44, v27, v31
    v_lshlrev_b32 v26, 16, v40
    v_lshlrev_b32 v27, 16, v44
    v_and_b32 v30, 0xffff0000, v40
    v_and_b32 v31, 0xffff0000, v44
    v_mul_f32 v41, 0xbfb8aa3b, v26
    v_mul_f32 v45, 0xbfb8aa3b, v27
    v_mul_f32 v42, 0xbfb8aa3b, v30
    v_mul_f32 v46, 0xbfb8aa3b, v31
    v_exp_f32 v41, v41
    v_exp_f32 v45, v45
    v_exp_f32 v42, v42
    v_exp_f32 v46, v46
    v_add_f32 v41, 1.0, v41
    v_add_f32 v45, 1.0, v45
    v_add_f32 v42, 1.0, v42
    v_add_f32 v46, 1.0, v46
    v_rcp_f32 v41, v41
    v_rcp_f32 v45, v45
    v_rcp_f32 v42, v42
    v_rcp_f32 v46, v46
    v_mul_f32 v26, v26, v41
    v_mul_f32 v27, v27, v45
    v_mul_f32 v30, v30, v42
    v_mul_f32 v31, v31, v46
    v_cvt_pk_bf16_f32 v43, v26, v30
    v_cvt_pk_bf16_f32 v47, v27, v31
    ds_write_b32 v118, v43 offset:4096
    ds_write_b32 v119, v47 offset:4096
    s_waitcnt lgkmcnt(0)
    s_barrier
    s_mov_b32 s36, s20
    s_mov_b32 s37, s21
    s_mov_b32 s38, 0x753000
    s_mov_b32 s39, 0x20000
K1_SP_O0:
    ds_read_b32 v13, v10 offset:16
    s_waitcnt lgkmcnt(0)
    v_readfirstlane_b32 s46, v13
    s_nop 0
    s_cmp_lt_u32 s46, 8
    s_nop 1
    s_cbranch_scc0 K1_SX_O0
    s_sleep 1
    s_branch K1_SP_O0
K1_SX_O0:
    ds_read_b128 v[16:19], v127 offset:0
    ds_read_b128 v[20:23], v127 offset:8192
    ds_read_b128 v[24:27], v127 offset:16384
    s_add_u32 s57, s56, 0
    s_waitcnt lgkmcnt(2)
    buffer_store_dwordx4 v[16:19], v126, s[36:39], s57 offen sc1
    s_add_u32 s57, s56, 8192
    s_waitcnt lgkmcnt(1)
    buffer_store_dwordx4 v[20:23], v126, s[36:39], s57 offen sc1
    s_add_u32 s57, s56, 16384
    s_waitcnt lgkmcnt(0)
    buffer_store_dwordx4 v[24:27], v126, s[36:39], s57 offen sc1
K1_SP_O1:
    ds_read_b32 v13, v10 offset:20
    s_waitcnt lgkmcnt(0)
    v_readfirstlane_b32 s46, v13
    s_nop 0
    s_cmp_lt_u32 s46, 8
    s_nop 1
    s_cbranch_scc0 K1_SX_O1
    s_sleep 1
    s_branch K1_SP_O1
K1_SX_O1:
    ds_read_b128 v[16:19], v127 offset:24576
    ds_read_b128 v[20:23], v127 offset:32768
    ds_read_b128 v[24:27], v127 offset:40960
    s_add_u32 s57, s56, 24576
    s_waitcnt lgkmcnt(2)
    buffer_store_dwordx4 v[16:19], v126, s[36:39], s57 offen sc1
    s_add_u32 s57, s56, 32768
    s_waitcnt lgkmcnt(1)
    buffer_store_dwordx4 v[20:23], v126, s[36:39], s57 offen sc1
    s_add_u32 s57, s56, 40960
    s_waitcnt lgkmcnt(0)
    buffer_store_dwordx4 v[24:27], v126, s[36:39], s57 offen sc1
    s_endpgm
K1_EDGE:
    s_sub_u32 s22, s2, 157
    v_lshlrev_b32 v3, 4, v0
    v_mul_u32_u24 v2, 24, v0
    s_mul_i32 s23, s22, 24576
    v_mov_b32 v24, -1
    v_mov_b32 v25, -1
    v_mov_b32 v26, -1
    v_mov_b32 v27, -1
    v_mov_b32 v28, 0
    v_lshlrev_b32 v29, 2, v0
    ds_write_b128 v3, v[24:27] offset:0
    s_cmp_ge_u32 s3, 4
    s_cbranch_scc1 K1_E1
    ds_write_b32 v29, v28 offset:16384
K1_E1:
    s_lshl_b32 s48, s3, 10
    v_lshlrev_b32 v30, 4, v1
    s_add_u32 s64, s43, 0
    s_and_b32 s64, s64, 3
    s_lshl_b32 s64, s64, 14
    s_add_u32 s64, s64, s48
    s_add_u32 s65, s43, 1
    s_and_b32 s65, s65, 3
    s_lshl_b32 s65, s65, 14
    s_add_u32 s65, s65, s48
    s_add_u32 s66, s43, 2
    s_and_b32 s66, s66, 3
    s_lshl_b32 s66, s66, 14
    s_add_u32 s66, s66, s48
    s_add_u32 s67, s43, 3
    s_and_b32 s67, s67, 3
    s_lshl_b32 s67, s67, 14
    s_add_u32 s67, s67, s48
    s_waitcnt lgkmcnt(0)
    s_mov_b32 s32, s6
    s_mov_b32 s33, s7
    s_mov_b32 s34, 0xea60
    s_mov_b32 s35, 0x20000
    s_mov_b32 s24, s8
    s_mov_b32 s25, s9
    s_mov_b32 s26, 0x138800
    s_mov_b32 s27, 0x20000
    s_mov_b32 s28, s10
    s_mov_b32 s29, s11
    s_mov_b32 s30, 0x138800
    s_mov_b32 s31, 0x20000
    buffer_load_dwordx4 v[4:7], v2, s[24:27], s23 offen
    buffer_load_dwordx2 v[8:9], v2, s[24:27], s23 offen offset:16
    buffer_load_dwordx4 v[12:15], v2, s[28:31], s23 offen
    buffer_load_dwordx2 v[16:17], v2, s[28:31], s23 offen offset:16
    s_cmp_ge_u32 s64, 61440
    s_cbranch_scc1 K1_E2_0
    s_add_u32 m0, s64, 17408
    s_nop 0
    buffer_load_dwordx4 v30, s[32:35], s64 offen lds
K1_E2_0:
    s_cmp_ge_u32 s65, 61440
    s_cbranch_scc1 K1_E2_1
    s_add_u32 m0, s65, 17408
    s_nop 0
    buffer_load_dwordx4 v30, s[32:35], s65 offen lds
K1_E2_1:
    s_cmp_ge_u32 s66, 61440
    s_cbranch_scc1 K1_E2_2
    s_add_u32 m0, s66, 17408
    s_nop 0
    buffer_load_dwordx4 v30, s[32:35], s66 offen lds
K1_E2_2:
    s_cmp_ge_u32 s67, 61440
    s_cbranch_scc1 K1_E2_3
    s_add_u32 m0, s67, 17408
    s_nop 0
    buffer_load_dwordx4 v30, s[32:35], s67 offen lds
K1_E2_3:
    s_mul_i32 s52, s22, 16384
    s_add_u32 s52, s52, 0x780000
    s_add_u32 s36, s20, s52
    s_addc_u32 s37, s21, 0
    s_mov_b32 s38, 16384
    s_mov_b32 s39, 0x20000
    s_mov_b32 s56, 0x41cc0000
    s_mov_b32 s68, 17408
    v_mov_b32 v30, 0x203
    v_mov_b32 v29, 1
    v_add_u32 v31, s23, v2
    s_waitcnt vmcnt(0)
    s_barrier
    v_mad_u32_u24 v20, v4, 6, s68
    v_and_b32 v20, -4, v20
    ds_read2_b32 v[32:33], v20 offset0:0 offset1:1
    v_mad_u32_u24 v21, v12, 6, s68
    v_and_b32 v21, -4, v21
    ds_read2_b32 v[34:35], v21 offset0:0 offset1:1
    v_mad_u32_u24 v20, v5, 6, s68
    v_and_b32 v20, -4, v20
    ds_read2_b32 v[36:37], v20 offset0:0 offset1:1
    v_mad_u32_u24 v21, v13, 6, s68
    v_and_b32 v21, -4, v21
    ds_read2_b32 v[38:39], v21 offset0:0 offset1:1
    v_mad_u32_u24 v20, v6, 6, s68
    v_and_b32 v20, -4, v20
    ds_read2_b32 v[40:41], v20 offset0:0 offset1:1
    v_mad_u32_u24 v21, v14, 6, s68
    v_and_b32 v21, -4, v21
    ds_read2_b32 v[42:43], v21 offset0:0 offset1:1
    v_mad_u32_u24 v20, v7, 6, s68
    v_and_b32 v20, -4, v20
    ds_read2_b32 v[44:45], v20 offset0:0 offset1:1
    v_mad_u32_u24 v21, v15, 6, s68
    v_and_b32 v21, -4, v21
    ds_read2_b32 v[46:47], v21 offset0:0 offset1:1
    v_mad_u32_u24 v20, v8, 6, s68
    v_and_b32 v20, -4, v20
    ds_read2_b32 v[48:49], v20 offset0:0 offset1:1
    v_mad_u32_u24 v21, v16, 6, s68
    v_and_b32 v21, -4, v21
    ds_read2_b32 v[50:51], v21 offset0:0 offset1:1
    v_mad_u32_u24 v20, v9, 6, s68
    v_and_b32 v20, -4, v20
    ds_read2_b32 v[52:53], v20 offset0:0 offset1:1
    v_mad_u32_u24 v21, v17, 6, s68
    v_and_b32 v21, -4, v21
    ds_read2_b32 v[54:55], v21 offset0:0 offset1:1
    v_mul_u32_u24 v56, 53602, v12
    v_lshrrev_b32 v56, 24, v56
    v_lshl_or_b32 v68, v12, 14, v4
    s_mov_b32 s57, 1280000
    v_cmp_gt_u32 s[58:59], s57, v31
    s_waitcnt lgkmcnt(10)
    v_and_b32 v86, 1, v4
    v_lshlrev_b32 v86, 4, v86
    v_alignbit_b32 v81, v33, v32, v86
    v_lshrrev_b32 v82, v86, v33
    v_lshlrev_b32 v80, 16, v81
    v_and_b32 v81, 0xffff0000, v81
    v_lshlrev_b32 v82, 16, v82
    v_and_b32 v87, 1, v12
    v_lshlrev_b32 v87, 4, v87
    v_alignbit_b32 v84, v35, v34, v87
    v_lshrrev_b32 v85, v87, v35
    v_lshlrev_b32 v83, 16, v84
    v_and_b32 v84, 0xffff0000, v84
    v_lshlrev_b32 v85, 16, v85
    v_sub_f32 v80, v80, v83
    v_sub_f32 v81, v81, v84
    v_sub_f32 v82, v82, v85
    v_alignbit_b32 v56, v56, v83, 31
    v_alignbit_b32 v56, v56, v84, 31
    v_lshlrev_b32 v56, 2, v56
    v_mul_f32 v80, v80, v80
    v_fmac_f32 v80, v81, v81
    v_fmac_f32 v80, v82, v82
    v_cmp_gt_f32 s[50:51], s56, v80
    v_cmp_class_f32 vcc, v80, v30
    s_nop 0
    s_or_b64 vcc, vcc, s[50:51]
    s_and_b64 s[58:59], vcc, s[58:59]
    s_mov_b64 exec, s[58:59]
    ds_add_rtn_u32 v62, v56, v29 offset:16384
    s_mov_b64 exec, -1
    v_mul_u32_u24 v57, 53602, v13
    v_lshrrev_b32 v57, 24, v57
    v_lshl_or_b32 v69, v13, 14, v5
    s_mov_b32 s57, 1279996
    v_cmp_gt_u32 s[60:61], s57, v31
    s_waitcnt lgkmcnt(9)
    v_and_b32 v86, 1, v5
    v_lshlrev_b32 v86, 4, v86
    v_alignbit_b32 v81, v37, v36, v86
    v_lshrrev_b32 v82, v86, v37
    v_lshlrev_b32 v80, 16, v81
    v_and_b32 v81, 0xffff0000, v81
    v_lshlrev_b32 v82, 16, v82
    v_and_b32 v87, 1, v13
    v_lshlrev_b32 v87, 4, v87
    v_alignbit_b32 v84, v39, v38, v87
    v_lshrrev_b32 v85, v87, v39
    v_lshlrev_b32 v83, 16, v84
    v_and_b32 v84, 0xffff0000, v84
    v_lshlrev_b32 v85, 16, v85
    v_sub_f32 v80, v80, v83
    v_sub_f32 v81, v81, v84
    v_sub_f32 v82, v82, v85
    v_alignbit_b32 v57, v57, v83, 31
    v_alignbit_b32 v57, v57, v84, 31
    v_lshlrev_b32 v57, 2, v57
    v_mul_f32 v80, v80, v80
    v_fmac_f32 v80, v81, v81
    v_fmac_f32 v80, v82, v82
    v_cmp_gt_f32 s[50:51], s56, v80
    v_cmp_class_f32 vcc, v80, v30
    s_nop 0
    s_or_b64 vcc, vcc, s[50:51]
    s_and_b64 s[60:61], vcc, s[60:61]
    s_mov_b64 exec, s[60:61]
    ds_add_rtn_u32 v63, v57, v29 offset:16384
    s_mov_b64 exec, -1
    v_mul_u32_u24 v58, 53602, v14
    v_lshrrev_b32 v58, 24, v58
    v_lshl_or_b32 v70, v14, 14, v6
    s_mov_b32 s57, 1279992
    v_cmp_gt_u32 s[62:63], s57, v31
    s_waitcnt lgkmcnt(8)
    v_and_b32 v86, 1, v6
    v_lshlrev_b32 v86, 4, v86
    v_alignbit_b32 v81, v41, v40, v86
    v_lshrrev_b32 v82, v86, v41
    v_lshlrev_b32 v80, 16, v81
    v_and_b32 v81, 0xffff0000, v81
    v_lshlrev_b32 v82, 16, v82
    v_and_b32 v87, 1, v14
    v_lshlrev_b32 v87, 4, v87
    v_alignbit_b32 v84, v43, v42, v87
    v_lshrrev_b32 v85, v87, v43
    v_lshlrev_b32 v83, 16, v84
    v_and_b32 v84, 0xffff0000, v84
    v_lshlrev_b32 v85, 16, v85
    v_sub_f32 v80, v80, v83
    v_sub_f32 v81, v81, v84
    v_sub_f32 v82, v82, v85
    v_alignbit_b32 v58, v58, v83, 31
    v_alignbit_b32 v58, v58, v84, 31
    v_lshlrev_b32 v58, 2, v58
    v_mul_f32 v80, v80, v80
    v_fmac_f32 v80, v81, v81
    v_fmac_f32 v80, v82, v82
    v_cmp_gt_f32 s[50:51], s56, v80
    v_cmp_class_f32 vcc, v80, v30
    s_nop 0
    s_or_b64 vcc, vcc, s[50:51]
    s_and_b64 s[62:63], vcc, s[62:63]
    s_mov_b64 exec, s[62:63]
    ds_add_rtn_u32 v64, v58, v29 offset:16384
    s_mov_b64 exec, -1
    v_mul_u32_u24 v59, 53602, v15
    v_lshrrev_b32 v59, 24, v59
    v_lshl_or_b32 v71, v15, 14, v7
    s_mov_b32 s57, 1279988
    v_cmp_gt_u32 s[64:65], s57, v31
    s_waitcnt lgkmcnt(7)
    v_and_b32 v86, 1, v7
    v_lshlrev_b32 v86, 4, v86
    v_alignbit_b32 v81, v45, v44, v86
    v_lshrrev_b32 v82, v86, v45
    v_lshlrev_b32 v80, 16, v81
    v_and_b32 v81, 0xffff0000, v81
    v_lshlrev_b32 v82, 16, v82
    v_and_b32 v87, 1, v15
    v_lshlrev_b32 v87, 4, v87
    v_alignbit_b32 v84, v47, v46, v87
    v_lshrrev_b32 v85, v87, v47
    v_lshlrev_b32 v83, 16, v84
    v_and_b32 v84, 0xffff0000, v84
    v_lshlrev_b32 v85, 16, v85
    v_sub_f32 v80, v80, v83
    v_sub_f32 v81, v81, v84
    v_sub_f32 v82, v82, v85
    v_alignbit_b32 v59, v59, v83, 31
    v_alignbit_b32 v59, v59, v84, 31
    v_lshlrev_b32 v59, 2, v59
    v_mul_f32 v80, v80, v80
    v_fmac_f32 v80, v81, v81
    v_fmac_f32 v80, v82, v82
    v_cmp_gt_f32 s[50:51], s56, v80
    v_cmp_class_f32 vcc, v80, v30
    s_nop 0
    s_or_b64 vcc, vcc, s[50:51]
    s_and_b64 s[64:65], vcc, s[64:65]
    s_mov_b64 exec, s[64:65]
    ds_add_rtn_u32 v65, v59, v29 offset:16384
    s_mov_b64 exec, -1
    v_mul_u32_u24 v60, 53602, v16
    v_lshrrev_b32 v60, 24, v60
    v_lshl_or_b32 v72, v16, 14, v8
    s_mov_b32 s57, 1279984
    v_cmp_gt_u32 s[66:67], s57, v31
    s_waitcnt lgkmcnt(6)
    v_and_b32 v86, 1, v8
    v_lshlrev_b32 v86, 4, v86
    v_alignbit_b32 v81, v49, v48, v86
    v_lshrrev_b32 v82, v86, v49
    v_lshlrev_b32 v80, 16, v81
    v_and_b32 v81, 0xffff0000, v81
    v_lshlrev_b32 v82, 16, v82
    v_and_b32 v87, 1, v16
    v_lshlrev_b32 v87, 4, v87
    v_alignbit_b32 v84, v51, v50, v87
    v_lshrrev_b32 v85, v87, v51
    v_lshlrev_b32 v83, 16, v84
    v_and_b32 v84, 0xffff0000, v84
    v_lshlrev_b32 v85, 16, v85
    v_sub_f32 v80, v80, v83
    v_sub_f32 v81, v81, v84
    v_sub_f32 v82, v82, v85
    v_alignbit_b32 v60, v60, v83, 31
    v_alignbit_b32 v60, v60, v84, 31
    v_lshlrev_b32 v60, 2, v60
    v_mul_f32 v80, v80, v80
    v_fmac_f32 v80, v81, v81
    v_fmac_f32 v80, v82, v82
    v_cmp_gt_f32 s[50:51], s56, v80
    v_cmp_class_f32 vcc, v80, v30
    s_nop 0
    s_or_b64 vcc, vcc, s[50:51]
    s_and_b64 s[66:67], vcc, s[66:67]
    s_mov_b64 exec, s[66:67]
    ds_add_rtn_u32 v66, v60, v29 offset:16384
    s_mov_b64 exec, -1
    v_mul_u32_u24 v61, 53602, v17
    v_lshrrev_b32 v61, 24, v61
    v_lshl_or_b32 v73, v17, 14, v9
    s_mov_b32 s57, 1279980
    v_cmp_gt_u32 s[46:47], s57, v31
    s_waitcnt lgkmcnt(5)
    v_and_b32 v86, 1, v9
    v_lshlrev_b32 v86, 4, v86
    v_alignbit_b32 v81, v53, v52, v86
    v_lshrrev_b32 v82, v86, v53
    v_lshlrev_b32 v80, 16, v81
    v_and_b32 v81, 0xffff0000, v81
    v_lshlrev_b32 v82, 16, v82
    v_and_b32 v87, 1, v17
    v_lshlrev_b32 v87, 4, v87
    v_alignbit_b32 v84, v55, v54, v87
    v_lshrrev_b32 v85, v87, v55
    v_lshlrev_b32 v83, 16, v84
    v_and_b32 v84, 0xffff0000, v84
    v_lshlrev_b32 v85, 16, v85
    v_sub_f32 v80, v80, v83
    v_sub_f32 v81, v81, v84
    v_sub_f32 v82, v82, v85
    v_alignbit_b32 v61, v61, v83, 31
    v_alignbit_b32 v61, v61, v84, 31
    v_lshlrev_b32 v61, 2, v61
    v_mul_f32 v80, v80, v80
    v_fmac_f32 v80, v81, v81
    v_fmac_f32 v80, v82, v82
    v_cmp_gt_f32 s[50:51], s56, v80
    v_cmp_class_f32 vcc, v80, v30
    s_nop 0
    s_or_b64 vcc, vcc, s[50:51]
    s_and_b64 s[46:47], vcc, s[46:47]
    s_mov_b64 exec, s[46:47]
    ds_add_rtn_u32 v67, v61, v29 offset:16384
    s_mov_b64 exec, -1
    s_mov_b64 s[50:51], 0
    s_waitcnt lgkmcnt(5)
    v_cmp_gt_u32 vcc, 31, v62
    v_lshl_add_u32 v80, v56, 3, v62
    v_lshlrev_b32 v80, 2, v80
    s_and_b64 exec, vcc, s[58:59]
    ds_write_b32 v80, v68 offset:0
    s_andn2_b64 s[58:59], s[58:59], vcc
    s_or_b64 s[50:51], s[50:51], s[58:59]
    s_mov_b64 exec, -1
    s_waitcnt lgkmcnt(5)
    v_cmp_gt_u32 vcc, 31, v63
    v_lshl_add_u32 v80, v57, 3, v63
    v_lshlrev_b32 v80, 2, v80
    s_and_b64 exec, vcc, s[60:61]
    ds_write_b32 v80, v69 offset:0
    s_andn2_b64 s[60:61], s[60:61], vcc
    s_or_b64 s[50:51], s[50:51], s[60:61]
    s_mov_b64 exec, -1
    s_waitcnt lgkmcnt(5)
    v_cmp_gt_u32 vcc, 31, v64
    v_lshl_add_u32 v80, v58, 3, v64
    v_lshlrev_b32 v80, 2, v80
    s_and_b64 exec, vcc, s[62:63]
    ds_write_b32 v80, v70 offset:0
    s_andn2_b64 s[62:63], s[62:63], vcc
    s_or_b64 s[50:51], s[50:51], s[62:63]
    s_mov_b64 exec, -1
    s_waitcnt lgkmcnt(5)
    v_cmp_gt_u32 vcc, 31, v65
    v_lshl_add_u32 v80, v59, 3, v65
    v_lshlrev_b32 v80, 2, v80
    s_and_b64 exec, vcc, s[64:65]
    ds_write_b32 v80, v71 offset:0
    s_andn2_b64 s[64:65], s[64:65], vcc
    s_or_b64 s[50:51], s[50:51], s[64:65]
    s_mov_b64 exec, -1
    s_waitcnt lgkmcnt(5)
    v_cmp_gt_u32 vcc, 31, v66
    v_lshl_add_u32 v80, v60, 3, v66
    v_lshlrev_b32 v80, 2, v80
    s_and_b64 exec, vcc, s[66:67]
    ds_write_b32 v80, v72 offset:0
    s_andn2_b64 s[66:67], s[66:67], vcc
    s_or_b64 s[50:51], s[50:51], s[66:67]
    s_mov_b64 exec, -1
    s_waitcnt lgkmcnt(5)
    v_cmp_gt_u32 vcc, 31, v67
    v_lshl_add_u32 v80, v61, 3, v67
    v_lshlrev_b32 v80, 2, v80
    s_and_b64 exec, vcc, s[46:47]
    ds_write_b32 v80, v73 offset:0
    s_andn2_b64 s[46:47], s[46:47], vcc
    s_or_b64 s[50:51], s[50:51], s[46:47]
    s_mov_b64 exec, -1
    s_cmp_eq_u64 s[50:51], 0
    s_cbranch_scc1 K1_NOSPILL
    s_add_u32 s72, s20, 0xa10000
    s_addc_u32 s73, s21, 0
    s_mov_b32 s74, 0x13e000
    s_mov_b32 s75, 0x20000
    s_mul_i32 s57, s22, 24576
    v_mov_b32 v22, 0
    v_mov_b32 v23, 0xfffffffe
    s_mov_b64 exec, s[58:59]
    s_cbranch_execz K1_SP0
    ds_add_rtn_u32 v80, v22, v29 offset:16896
    v_lshlrev_b32 v81, 5, v56
    ds_write_b32 v81, v23 offset:124
    s_waitcnt lgkmcnt(0)
    v_lshlrev_b32 v80, 2, v80
    buffer_store_dword v68, v80, s[72:75], s57 offen
K1_SP0:
    s_mov_b64 exec, s[60:61]
    s_cbranch_execz K1_SP1
    ds_add_rtn_u32 v80, v22, v29 offset:16896
    v_lshlrev_b32 v81, 5, v57
    ds_write_b32 v81, v23 offset:124
    s_waitcnt lgkmcnt(0)
    v_lshlrev_b32 v80, 2, v80
    buffer_store_dword v69, v80, s[72:75], s57 offen
K1_SP1:
    s_mov_b64 exec, s[62:63]
    s_cbranch_execz K1_SP2
    ds_add_rtn_u32 v80, v22, v29 offset:16896
    v_lshlrev_b32 v81, 5, v58
    ds_write_b32 v81, v23 offset:124
    s_waitcnt lgkmcnt(0)
    v_lshlrev_b32 v80, 2, v80
    buffer_store_dword v70, v80, s[72:75], s57 offen
K1_SP2:
    s_mov_b64 exec, s[64:65]
    s_cbranch_execz K1_SP3
    ds_add_rtn_u32 v80, v22, v29 offset:16896
    v_lshlrev_b32 v81, 5, v59
    ds_write_b32 v81, v23 offset:124
    s_waitcnt lgkmcnt(0)
    v_lshlrev_b32 v80, 2, v80
    buffer_store_dword v71, v80, s[72:75], s57 offen
K1_SP3:
    s_mov_b64 exec, s[66:67]
    s_cbranch_execz K1_SP4
    ds_add_rtn_u32 v80, v22, v29 offset:16896
    v_lshlrev_b32 v81, 5, v60
    ds_write_b32 v81, v23 offset:124
    s_waitcnt lgkmcnt(0)
    v_lshlrev_b32 v80, 2, v80
    buffer_store_dword v72, v80, s[72:75], s57 offen
K1_SP4:
    s_mov_b64 exec, s[46:47]
    s_cbranch_execz K1_SP5
    ds_add_rtn_u32 v80, v22, v29 offset:16896
    v_lshlrev_b32 v81, 5, v61
    ds_write_b32 v81, v23 offset:124
    s_waitcnt lgkmcnt(0)
    v_lshlrev_b32 v80, 2, v80
    buffer_store_dword v73, v80, s[72:75], s57 offen
K1_SP5:
    s_mov_b64 exec, -1
K1_NOSPILL:
    s_waitcnt lgkmcnt(0)
    s_barrier
    ds_read_b128 v[4:7], v3 offset:0
    v_mov_b32 v20, 0
    ds_read_b32 v21, v20 offset:16896
    s_waitcnt lgkmcnt(1)
    buffer_store_dwordx4 v[4:7], v3, s[36:39], 0 offen sc1
    s_cmp_lg_u32 s3, 0
    s_cbranch_scc1 K1_END
    s_add_u32 s64, s20, 0xa00000
    s_addc_u32 s65, s21, 0
    s_mov_b32 s66, 0xd4
    s_mov_b32 s67, 0x20000
    s_lshl_b32 s57, s22, 2
    s_mov_b64 exec, 1
    s_waitcnt lgkmcnt(0)
    buffer_store_dword v21, v20, s[64:67], s57 offen
K1_END:
    s_endpgm
K1_PF:
    s_sub_u32 s58, s2, 210
    s_mul_i32 s58, s58, 208
    s_waitcnt lgkmcnt(0)
    s_mov_b32 s24, s4
    s_mov_b32 s25, s5
    s_mov_b32 s26, 0x9c4000
    s_mov_b32 s27, 0x20000
    v_lshlrev_b32 v100, 4, v1
    s_mul_i32 s57, s3, 13
    s_add_u32 s57, s57, s58
    s_lshl_b32 s57, s57, 10
    s_mov_b32 exec_lo, -1
    s_mov_b32 exec_hi, 0xffff
    buffer_load_dwordx4 v[104:107], v100, s[24:27], s57 offen offset:256
    buffer_load_dwordx4 v[104:107], v100, s[24:27], s57 offen offset:1280
    buffer_load_dwordx4 v[104:107], v100, s[24:27], s57 offen offset:2304
    s_add_u32 s57, s57, 3072
    buffer_load_dwordx4 v[104:107], v100, s[24:27], s57 offen offset:256
    buffer_load_dwordx4 v[104:107], v100, s[24:27], s57 offen offset:1280
    buffer_load_dwordx4 v[104:107], v100, s[24:27], s57 offen offset:2304
    s_add_u32 s57, s57, 3072
    buffer_load_dwordx4 v[104:107], v100, s[24:27], s57 offen offset:256
    buffer_load_dwordx4 v[104:107], v100, s[24:27], s57 offen offset:1280
    buffer_load_dwordx4 v[104:107], v100, s[24:27], s57 offen offset:2304
    s_add_u32 s57, s57, 3072
    buffer_load_dwordx4 v[104:107], v100, s[24:27], s57 offen offset:256
    buffer_load_dwordx4 v[104:107], v100, s[24:27], s57 offen offset:1280
    buffer_load_dwordx4 v[104:107], v100, s[24:27], s57 offen offset:2304
    s_add_u32 s57, s57, 3072
    buffer_load_dwordx4 v[104:107], v100, s[24:27], s57 offen offset:256
    s_mov_b64 exec, -1
    s_endpgm
.globl painn_k2_kernel
.p2align 8
.type painn_k2_kernel,@function
painn_k2_kernel:
    s_cmp_ge_u32 s2, 256
    s_cbranch_scc1 K2_END
    s_load_dwordx4 s[4:7], s[0:1], 0
    s_load_dwordx2 s[8:9], s[0:1], 32
    s_load_dwordx4 s[36:39], s[0:1], 56
    s_load_dwordx2 s[10:11], s[0:1], 80
    v_and_b32 v116, 63, v0
    v_lshrrev_b32 v117, 6, v0
    s_nop 0
    v_readfirstlane_b32 s43, v117
    s_and_b32 s49, s2, 1
    s_lshr_b32 s48, s2, 1
    s_lshr_b32 s57, s2, 3
    s_mul_i32 s42, s57, 313
    s_movk_i32 s74, 768
    v_mov_b32 v120, 0xffffff
    v_mov_b32 v121, 0xffffff
    v_mov_b32 v122, 0xffffff
    v_mov_b32 v123, 0xffffff
    v_lshlrev_b32 v118, 4, v0
    v_add_u32 v119, 46592, v118
    ds_write_b128 v119, v[120:123] offset:0
    ds_write_b128 v119, v[120:123] offset:12288
    ds_write_b128 v119, v[120:123] offset:24576
    s_cmp_ge_u32 s43, 4
    s_cbranch_scc1 K2_I0
    ds_write_b128 v119, v[120:123] offset:36864
K2_I0:
    s_cmp_ge_u32 s43, 2
    s_cbranch_scc1 K2_I1
    v_mov_b32 v120, 0x1390139
    v_mov_b32 v121, 0x1390139
    v_mov_b32 v122, 0x1390139
    v_mov_b32 v123, 0x1390139
    ds_write_b128 v118, v[120:123] offset:1536
    s_branch K2_I2
K2_I1:
    s_cmp_ge_u32 s43, 8
    s_cbranch_scc1 K2_I2
    v_mov_b32 v120, 0
    v_mov_b32 v121, 0
    v_mov_b32 v122, 0
    v_mov_b32 v123, 0
    s_cmp_ge_u32 s43, 6
    s_cbranch_scc1 K2_I3
    ds_write_b128 v118, v[120:123] offset:5632
    ds_write_b128 v118, v[120:123] offset:9728
    s_branch K2_I2
K2_I3:
    v_subrev_u32 v119, 6144, v118
    v_cmp_gt_u32 vcc, 1536, v119
    s_nop 0
    s_and_saveexec_b64 s[72:73], vcc
    ds_write_b128 v119, v[120:123]
    s_andn2_b64 exec, s[72:73], vcc
    v_and_b32 v119, 16, v119
    ds_write_b128 v119, v[120:123] offset:46560
    s_mov_b64 exec, -1
K2_I2:
    v_and_b32 v118, 7, v116
    v_lshlrev_b32 v6, 4, v118
    s_mul_i32 s57, s49, 384
    v_add_u32 v1, s57, v6
    s_lshl_b32 s57, s49, 7
    v_add_u32 v3, s57, v6
    v_add_u32 v2, 256, v3
    v_bfe_u32 v119, v116, 3, 2
    v_lshl_add_u32 v166, v119, 8, v3
    v_lshlrev_b32 v167, 2, v119
    v_lshrrev_b32 v164, 5, v116
    v_lshlrev_b32 v164, 1, v164
    v_bfe_u32 v119, v116, 3, 1
    v_lshl_add_u32 v3, v119, 8, v3
    v_lshlrev_b32 v4, 2, v119
    v_bfe_u32 v119, v116, 2, 2
    v_lshlrev_b32 v5, 6, v119
    v_add_u32 v10, 32, v5
    v_lshlrev_b32 v6, 4, v116
    v_mov_b32 v7, 1
    v_lshrrev_b32 v8, 4, v116
    v_lshlrev_b32 v8, 1, v8
    v_mov_b32 v9, 0x7ffffff0
    v_mov_b32 v12, v9
    v_mov_b32 v22, v9
    v_mov_b32 v23, v9
    v_mov_b32 v16, v9
    v_mov_b32 v18, v9
    v_mov_b32 v19, v9
    v_mov_b32 v20, 32736
    v_mov_b32 v21, 32736
    v_lshrrev_b32 v118, 3, v0
    v_and_b32 v119, 7, v0
    v_lshlrev_b32 v118, 7, v118
    v_add_u32 v118, s48, v118
    v_lshl_add_u32 v118, v118, 3, v119
    v_lshlrev_b32 v118, 4, v118
    v_lshrrev_b32 v119, 6, v0
    v_lshl_add_u32 v122, v119, 7, v116
    s_lshl_b32 s57, s49, 6
    v_add_lshl_u32 v122, v122, s57, 1
    s_mov_b32 s51, 0
    s_mov_b32 s44, 0
    s_waitcnt lgkmcnt(0)
    s_load_dwordx2 s[78:79], s[8:9], 0
    s_add_u32 s28, s10, 0x780000
    s_addc_u32 s29, s11, 0
    s_mov_b32 s30, 0xd4000
    s_mov_b32 s31, 0x20000
    s_mov_b32 s20, s6
    s_mov_b32 s21, s7
    s_mov_b32 s22, 0xea60
    s_mov_b32 s23, 0x20000
    s_mov_b32 s12, s4
    s_mov_b32 s13, s5
    s_mov_b32 s14, 0x9c4000
    s_mov_b32 s15, 0x20000
    s_mov_b32 s16, s10
    s_mov_b32 s17, s11
    s_mov_b32 s18, 0x753000
    s_mov_b32 s19, 0x20000
    s_mov_b32 s24, s38
    s_mov_b32 s25, s39
    s_mov_b32 s26, 0x9c4000
    s_mov_b32 s27, 0x20000
    s_mov_b32 s56, 0x10000000
    s_cmp_ge_u32 s43, 10
    s_cbranch_scc1 K2_PF
    buffer_load_dwordx4 v[132:135], v118, s[28:31], 0 offen
    s_cmp_ge_u32 s43, 3
    s_cbranch_scc1 K2_L2
    s_mov_b32 s32, s36
    s_mov_b32 s33, s37
    s_mov_b32 s34, 0xc00
    s_mov_b32 s35, 0x20000
    buffer_load_ushort v128, v122, s[32:35], 0 offen offset:0
    buffer_load_ushort v129, v122, s[32:35], 0 offen offset:768
    buffer_load_ushort v130, v122, s[32:35], 0 offen offset:1536
    buffer_load_ushort v131, v122, s[32:35], 0 offen offset:2304
K2_L2:
    s_movk_i32 s57, 424
    v_cmp_gt_u32 s[72:73], s57, v0
    s_mov_b32 s58, 0xfffffffe
    s_barrier
    s_cmp_lt_u32 s43, 3
    s_nop 0
    s_cbranch_scc1 K2_W4
    s_waitcnt vmcnt(0)
K2_W4:
    s_waitcnt vmcnt(4)
    s_mov_b32 s55, 0
    v_cmp_gt_u32 vcc, s56, v132
    v_lshrrev_b32 v136, 14, v132
    s_and_b64 s[60:61], vcc, s[72:73]
    v_and_b32 v124, 0x3fff, v132
    v_cmp_gt_u32 vcc, s56, v133
    v_lshrrev_b32 v137, 14, v133
    s_and_b64 s[62:63], vcc, s[72:73]
    v_and_b32 v125, 0x3fff, v133
    v_cmp_gt_u32 vcc, s56, v134
    v_lshrrev_b32 v138, 14, v134
    s_and_b64 s[64:65], vcc, s[72:73]
    v_and_b32 v126, 0x3fff, v134
    v_cmp_gt_u32 vcc, s56, v135
    v_lshrrev_b32 v139, 14, v135
    s_and_b64 s[66:67], vcc, s[72:73]
    v_and_b32 v127, 0x3fff, v135
    v_subrev_u32 v136, s42, v136
    v_lshlrev_b32 v140, 2, v136
    v_mbcnt_lo_u32_b32 v148, s60, 0
    v_mbcnt_hi_u32_b32 v148, s61, v148
    v_add_u32 v148, s55, v148
    s_bcnt1_i32_b64 s59, s[60:61]
    s_add_u32 s55, s55, s59
    s_mov_b64 exec, s[60:61]
    ds_add_rtn_u32 v144, v140, v7 offset:0
    s_mov_b64 exec, -1
    v_subrev_u32 v137, s42, v137
    v_lshlrev_b32 v141, 2, v137
    v_mbcnt_lo_u32_b32 v149, s62, 0
    v_mbcnt_hi_u32_b32 v149, s63, v149
    v_add_u32 v149, s55, v149
    s_bcnt1_i32_b64 s59, s[62:63]
    s_add_u32 s55, s55, s59
    s_mov_b64 exec, s[62:63]
    ds_add_rtn_u32 v145, v141, v7 offset:0
    s_mov_b64 exec, -1
    v_subrev_u32 v138, s42, v138
    v_lshlrev_b32 v142, 2, v138
    v_mbcnt_lo_u32_b32 v150, s64, 0
    v_mbcnt_hi_u32_b32 v150, s65, v150
    v_add_u32 v150, s55, v150
    s_bcnt1_i32_b64 s59, s[64:65]
    s_add_u32 s55, s55, s59
    s_mov_b64 exec, s[64:65]
    ds_add_rtn_u32 v146, v142, v7 offset:0
    s_mov_b64 exec, -1
    v_subrev_u32 v139, s42, v139
    v_lshlrev_b32 v143, 2, v139
    v_mbcnt_lo_u32_b32 v151, s66, 0
    v_mbcnt_hi_u32_b32 v151, s67, v151
    v_add_u32 v151, s55, v151
    s_bcnt1_i32_b64 s59, s[66:67]
    s_add_u32 s55, s55, s59
    s_mov_b64 exec, s[66:67]
    ds_add_rtn_u32 v147, v143, v7 offset:0
    s_mov_b64 exec, -1
    v_mov_b32 v118, 0
    v_mov_b32 v119, s55
    s_mov_b64 exec, 1
    ds_add_rtn_u32 v120, v118, v119 offset:1280
    s_mov_b64 exec, -1
    v_cmp_eq_u32 vcc, s58, v135
    s_nop 0
    s_and_b64 s[68:69], vcc, s[72:73]
    s_waitcnt lgkmcnt(0)
    v_readfirstlane_b32 s54, v120
    s_nop 1
    v_add_u32 v148, s54, v148
    v_cmp_gt_u32 vcc, 32, v144
    v_lshl_add_u32 v140, v136, 5, v144
    s_and_b64 s[70:71], s[60:61], vcc
    v_cmp_gt_u32 vcc, 1023, v148
    v_lshlrev_b32 v140, 2, v140
    s_and_b64 s[70:71], s[70:71], vcc
    s_andn2_b64 s[60:61], s[60:61], s[70:71]
    s_or_b64 s[68:69], s[68:69], s[60:61]
    s_mov_b64 s[60:61], s[70:71]
    v_lshl_or_b32 v120, v148, 14, v124
    v_lshlrev_b32 v148, 2, v148
    v_cmp_eq_u32 vcc, 12, v144
    s_mov_b64 exec, s[70:71]
    ds_write_b32 v140, v120 offset:46592
    ds_write_b32 v148, v132 offset:3584
    s_and_b64 exec, exec, vcc
    s_mov_b64 s[4:5], exec
    ds_add_rtn_u32 v144, v118, v7 offset:1312
    s_mov_b64 exec, -1
    v_add_u32 v149, s54, v149
    v_cmp_gt_u32 vcc, 32, v145
    v_lshl_add_u32 v141, v137, 5, v145
    s_and_b64 s[70:71], s[62:63], vcc
    v_cmp_gt_u32 vcc, 1023, v149
    v_lshlrev_b32 v141, 2, v141
    s_and_b64 s[70:71], s[70:71], vcc
    s_andn2_b64 s[62:63], s[62:63], s[70:71]
    s_or_b64 s[68:69], s[68:69], s[62:63]
    s_mov_b64 s[62:63], s[70:71]
    v_lshl_or_b32 v120, v149, 14, v125
    v_lshlrev_b32 v149, 2, v149
    v_cmp_eq_u32 vcc, 12, v145
    s_mov_b64 exec, s[70:71]
    ds_write_b32 v141, v120 offset:46592
    ds_write_b32 v149, v133 offset:3584
    s_and_b64 exec, exec, vcc
    s_mov_b64 s[6:7], exec
    ds_add_rtn_u32 v145, v118, v7 offset:1312
    s_mov_b64 exec, -1
    v_add_u32 v150, s54, v150
    v_cmp_gt_u32 vcc, 32, v146
    v_lshl_add_u32 v142, v138, 5, v146
    s_and_b64 s[70:71], s[64:65], vcc
    v_cmp_gt_u32 vcc, 1023, v150
    v_lshlrev_b32 v142, 2, v142
    s_and_b64 s[70:71], s[70:71], vcc
    s_andn2_b64 s[64:65], s[64:65], s[70:71]
    s_or_b64 s[68:69], s[68:69], s[64:65]
    s_mov_b64 s[64:65], s[70:71]
    v_lshl_or_b32 v120, v150, 14, v126
    v_lshlrev_b32 v150, 2, v150
    v_cmp_eq_u32 vcc, 12, v146
    s_mov_b64 exec, s[70:71]
    ds_write_b32 v142, v120 offset:46592
    ds_write_b32 v150, v134 offset:3584
    s_and_b64 exec, exec, vcc
    s_mov_b64 s[8:9], exec
    ds_add_rtn_u32 v146, v118, v7 offset:1312
    s_mov_b64 exec, -1
    v_add_u32 v151, s54, v151
    v_cmp_gt_u32 vcc, 32, v147
    v_lshl_add_u32 v143, v139, 5, v147
    s_and_b64 s[70:71], s[66:67], vcc
    v_cmp_gt_u32 vcc, 1023, v151
    v_lshlrev_b32 v143, 2, v143
    s_and_b64 s[70:71], s[70:71], vcc
    s_andn2_b64 s[66:67], s[66:67], s[70:71]
    s_or_b64 s[68:69], s[68:69], s[66:67]
    s_mov_b64 s[66:67], s[70:71]
    v_lshl_or_b32 v120, v151, 14, v127
    v_lshlrev_b32 v151, 2, v151
    v_cmp_eq_u32 vcc, 12, v147
    s_mov_b64 exec, s[70:71]
    ds_write_b32 v143, v120 offset:46592
    ds_write_b32 v151, v135 offset:3584
    s_and_b64 exec, exec, vcc
    s_mov_b64 s[76:77], exec
    ds_add_rtn_u32 v147, v118, v7 offset:1312
    s_mov_b64 exec, -1
    s_cmp_eq_u64 s[68:69], 0
    s_cbranch_scc1 K2_NOFL
    ds_write_b32 v118, v7 offset:1284
    s_mov_b32 s55, 0
K2_NOFL:
    s_waitcnt lgkmcnt(0)
    v_min_u32 v144, 511, v144
    v_lshlrev_b32 v144, 1, v144
    v_min_u32 v145, 511, v145
    v_lshlrev_b32 v145, 1, v145
    v_min_u32 v146, 511, v146
    v_lshlrev_b32 v146, 1, v146
    v_min_u32 v147, 511, v147
    v_lshlrev_b32 v147, 1, v147
    s_mov_b64 exec, s[4:5]
    ds_write_b16 v144, v136 offset:1536
    s_mov_b64 exec, s[6:7]
    ds_write_b16 v145, v137 offset:1536
    s_mov_b64 exec, s[8:9]
    ds_write_b16 v146, v138 offset:1536
    s_mov_b64 exec, s[76:77]
    ds_write_b16 v147, v139 offset:1536
    s_mov_b64 exec, 1
    ds_add_u32 v118, v7 offset:1308
    s_mov_b64 exec, -1
    s_cmp_ge_u32 s43, 3
    s_cbranch_scc1 K2_PW
    v_lshrrev_b32 v120, 6, v0
    v_bfe_u32 v119, v0, 2, 1
    v_mad_u32_u24 v120, v119, 3, v120
    v_lshlrev_b32 v120, 10, v120
    v_bfe_u32 v119, v0, 3, 3
    v_lshl_add_u32 v120, v119, 4, v120
    v_and_b32 v119, 3, v0
    v_lshl_add_u32 v120, v119, 8, v120
    s_waitcnt vmcnt(0)
    v_lshl_or_b32 v128, v129, 16, v128
    v_lshl_or_b32 v129, v131, 16, v130
    ds_write_b64 v120, v[128:129] offset:7680
    ds_write_b64 v120, v[128:129] offset:7816
K2_PW:
    v_and_b32 v0, 63, v0
    s_lshl_b32 s64, s78, 16
    s_and_b32 s65, s78, 0xffff0000
    s_lshl_b32 s66, s79, 16
    s_and_b32 s67, s79, 0xffff0000
    s_add_u32 s55, s55, s54
K2_GL:
    s_cmp_ge_u32 s54, s55
    s_cbranch_scc1 K2_GD
    v_add_u32 v34, s54, v0
    v_cmp_gt_u32 s[58:59], s55, v34
    v_lshlrev_b32 v40, 2, v34
    ds_read_b32 v33, v40 offset:3584
    v_lshlrev_b32 v34, 5, v34
    s_waitcnt lgkmcnt(0)
    s_mov_b64 exec, s[58:59]
    v_and_b32 v32, 0x3fff, v33
    v_lshrrev_b32 v33, 14, v33
    v_mul_u32_u24 v40, 6, v32
    v_mul_u32_u24 v41, 6, v33
    v_and_b32 v40, -4, v40
    v_and_b32 v41, -4, v41
    buffer_load_dwordx2 v[36:37], v40, s[20:23], 0 offen
    buffer_load_dwordx2 v[38:39], v41, s[20:23], 0 offen
    s_waitcnt vmcnt(0)
    s_call_b64 s[68:69], K2_GEOM
    s_mov_b64 exec, -1
    s_add_u32 s54, s54, 64
    s_branch K2_GL
K2_GD:
    s_mov_b64 exec, 1
    ds_add_u32 v118, v7 offset:1288
    s_mov_b64 exec, -1
    s_branch K2_B2
K2_PF:
    v_subrev_u32 v136, 640, v0
    v_add_u32 v137, 0, v136
    v_add_u32 v140, s42, v137
    v_mul_u32_u24 v143, 6, v140
    v_and_b32 v143, -4, v143
    buffer_load_dwordx2 v[144:145], v143, s[20:23], 0 offen
    v_add_u32 v138, 128, v136
    v_add_u32 v141, s42, v138
    v_mul_u32_u24 v143, 6, v141
    v_and_b32 v143, -4, v143
    buffer_load_dwordx2 v[146:147], v143, s[20:23], 0 offen
    v_add_u32 v139, 256, v136
    v_add_u32 v142, s42, v139
    v_mul_u32_u24 v143, 6, v142
    v_and_b32 v143, -4, v143
    buffer_load_dwordx2 v[148:149], v143, s[20:23], 0 offen
    v_and_b32 v0, 63, v0
    v_mov_b32 v118, 0
    s_and_b32 s58, s48, 3
    s_lshl_b32 s59, s49, 7
    s_barrier
    v_and_b32 v143, 1, v140
    v_lshlrev_b32 v143, 4, v143
    v_cmp_gt_u32 vcc, 313, v137
    s_nop 0
    s_mov_b64 s[60:61], vcc
    v_cmp_gt_u32 vcc, 10000, v140
    s_nop 0
    s_and_b64 s[60:61], s[60:61], vcc
    s_waitcnt vmcnt(2)
    v_alignbit_b32 v144, v145, v144, v143
    v_bfe_u32 v143, v144, 15, 1
    v_lshrrev_b32 v144, 31, v144
    v_lshl_add_u32 v143, v143, 1, v144
    v_cmp_eq_u32 vcc, s58, v143
    v_lshlrev_b32 v143, 10, v140
    s_and_b64 s[60:61], s[60:61], vcc
    s_mov_b64 s[66:67], s[60:61]
    s_mov_b64 exec, s[60:61]
    buffer_load_dword v75, v143, s[12:15], s59 offen offset:0
    buffer_load_dword v75, v143, s[12:15], s59 offen offset:256
    buffer_load_dword v75, v143, s[12:15], s59 offen offset:512
    buffer_load_dword v75, v143, s[12:15], s59 offen offset:768
    s_mov_b64 exec, -1
    v_and_b32 v143, 1, v141
    v_lshlrev_b32 v143, 4, v143
    v_cmp_gt_u32 vcc, 313, v138
    s_nop 0
    s_mov_b64 s[62:63], vcc
    v_cmp_gt_u32 vcc, 10000, v141
    s_nop 0
    s_and_b64 s[62:63], s[62:63], vcc
    s_waitcnt vmcnt(5)
    v_alignbit_b32 v146, v147, v146, v143
    v_bfe_u32 v143, v146, 15, 1
    v_lshrrev_b32 v146, 31, v146
    v_lshl_add_u32 v143, v143, 1, v146
    v_cmp_eq_u32 vcc, s58, v143
    v_lshlrev_b32 v143, 10, v141
    s_and_b64 s[62:63], s[62:63], vcc
    s_mov_b64 s[68:69], s[62:63]
    s_mov_b64 exec, s[62:63]
    buffer_load_dword v75, v143, s[12:15], s59 offen offset:0
    buffer_load_dword v75, v143, s[12:15], s59 offen offset:256
    buffer_load_dword v75, v143, s[12:15], s59 offen offset:512
    buffer_load_dword v75, v143, s[12:15], s59 offen offset:768
    s_mov_b64 exec, -1
    v_and_b32 v143, 1, v142
    v_lshlrev_b32 v143, 4, v143
    v_cmp_gt_u32 vcc, 313, v139
    s_nop 0
    s_mov_b64 s[64:65], vcc
    v_cmp_gt_u32 vcc, 10000, v142
    s_nop 0
    s_and_b64 s[64:65], s[64:65], vcc
    s_waitcnt vmcnt(8)
    v_alignbit_b32 v148, v149, v148, v143
    v_bfe_u32 v143, v148, 15, 1
    v_lshrrev_b32 v148, 31, v148
    v_lshl_add_u32 v143, v143, 1, v148
    v_cmp_eq_u32 vcc, s58, v143
    v_lshlrev_b32 v143, 10, v142
    s_and_b64 s[64:65], s[64:65], vcc
    s_mov_b64 s[70:71], s[64:65]
    s_mov_b64 exec, s[64:65]
    buffer_load_dword v75, v143, s[12:15], s59 offen offset:0
    buffer_load_dword v75, v143, s[12:15], s59 offen offset:256
    buffer_load_dword v75, v143, s[12:15], s59 offen offset:512
    buffer_load_dword v75, v143, s[12:15], s59 offen offset:768
    s_mov_b64 exec, -1
K2_B2:
K2_IW:
    ds_read_b32 v123, v118 offset:1308
    s_waitcnt lgkmcnt(0)
    v_readfirstlane_b32 s57, v123
    s_nop 0
    s_cmp_lt_u32 s57, 10
    s_nop 1
    s_cbranch_scc1 K2_IW
    ds_read_b64 v[120:121], v118 offset:1280
    ds_read_b32 v122, v118 offset:1312
    s_waitcnt lgkmcnt(0)
    v_readfirstlane_b32 s53, v121
    v_readfirstlane_b32 s9, v122
    s_nop 0
    s_add_u32 s9, s9, 1
    s_lshr_b32 s9, s9, 1
    s_cmp_eq_u32 s53, 0
    s_cselect_b32 s9, s9, 0
    s_min_u32 s75, s9, 10
    s_cmp_ge_u32 s43, 10
    s_cbranch_scc1 K2_SRT
    s_cmp_ge_u32 s43, s9
    s_cbranch_scc1 K2_MAIN
    v_mov_b32 v14, -1
    s_mov_b32 s50, s43
    s_cmp_lt_u32 s50, s9
    s_cselect_b32 s6, 1, 0
    s_cbranch_scc1 K2_NPHG
    s_sub_u32 s57, s50, s9
    s_lshl_b32 s57, s57, 2
    s_min_u32 s57, s57, 500
    v_cmp_ge_u32 vcc, s57, v14
    s_nop 0
    s_bcnt1_i32_b64 s72, vcc
    s_sub_u32 s52, 6, s72
    s_add_u32 s57, s57, 512
    v_lshl_add_u32 v13, s57, 1, v8
    s_nop 0
    s_branch K2_NPEG
K2_NPHG:
    s_lshl_b32 s57, s50, 2
    s_mov_b32 s52, 1
    v_add_u32 v13, s57, v164
K2_NPEG:
    ds_read_u16 v13, v13 offset:1536
    s_call_b64 s[62:63], K2_ISS_A
    s_cmp_eq_u32 s44, 0
    s_cbranch_scc1 K2_FE1
    buffer_load_dwordx4 v[116:119], v18, s[16:19], 0 offen offset:0
    buffer_load_dwordx4 v[120:123], v18, s[16:19], 0 offen offset:128
    buffer_load_dwordx4 v[124:127], v18, s[16:19], 0 offen offset:256
    buffer_load_dwordx4 v[128:131], v19, s[12:15], 0 offen offset:0
    buffer_load_dwordx4 v[132:135], v19, s[12:15], 0 offen offset:256
    buffer_load_dwordx4 v[136:139], v19, s[12:15], 0 offen offset:512
K2_FE1:
    s_call_b64 s[62:63], K2_ISS_B
    s_cmp_eq_u32 s45, 0
    s_cbranch_scc1 K2_FE2
    buffer_load_dwordx4 v[140:143], v18, s[16:19], 0 offen offset:0
    buffer_load_dwordx4 v[144:147], v18, s[16:19], 0 offen offset:128
    buffer_load_dwordx4 v[148:151], v18, s[16:19], 0 offen offset:256
    buffer_load_dwordx4 v[152:155], v19, s[12:15], 0 offen offset:0
    buffer_load_dwordx4 v[156:159], v19, s[12:15], 0 offen offset:256
    buffer_load_dwordx4 v[160:163], v19, s[12:15], 0 offen offset:512
K2_FE2:
    s_branch K2_MAIN
K2_SRT:
    v_min_u32 v120, 319, v137
    v_lshlrev_b32 v120, 2, v120
    ds_read_b32 v144, v120 offset:0
    v_min_u32 v120, 319, v138
    v_lshlrev_b32 v120, 2, v120
    ds_read_b32 v145, v120 offset:0
    v_min_u32 v120, 319, v139
    v_lshlrev_b32 v120, 2, v120
    ds_read_b32 v146, v120 offset:0
    s_waitcnt lgkmcnt(0)
    v_cmp_lt_u32 vcc, 12, v144
    v_add_u32 v147, 1, v144
    s_cmp_eq_u32 s53, 0
    s_cselect_b64 s[54:55], vcc, 0
    s_andn2_b64 s[60:61], s[60:61], s[54:55]
    v_lshrrev_b32 v147, 1, v147
    v_min_u32 v147, 6, v147
    v_sub_u32 v147, 6, v147
    v_lshlrev_b32 v147, 2, v147
    s_mov_b64 exec, s[60:61]
    ds_add_rtn_u32 v150, v147, v7 offset:1408
    s_mov_b64 exec, -1
    v_cmp_lt_u32 vcc, 12, v145
    v_add_u32 v148, 1, v145
    s_cmp_eq_u32 s53, 0
    s_cselect_b64 s[54:55], vcc, 0
    s_andn2_b64 s[62:63], s[62:63], s[54:55]
    v_lshrrev_b32 v148, 1, v148
    v_min_u32 v148, 6, v148
    v_sub_u32 v148, 6, v148
    v_lshlrev_b32 v148, 2, v148
    s_mov_b64 exec, s[62:63]
    ds_add_rtn_u32 v151, v148, v7 offset:1408
    s_mov_b64 exec, -1
    v_cmp_lt_u32 vcc, 12, v146
    v_add_u32 v149, 1, v146
    s_cmp_eq_u32 s53, 0
    s_cselect_b64 s[54:55], vcc, 0
    s_andn2_b64 s[64:65], s[64:65], s[54:55]
    v_lshrrev_b32 v149, 1, v149
    v_min_u32 v149, 6, v149
    v_sub_u32 v149, 6, v149
    v_lshlrev_b32 v149, 2, v149
    s_mov_b64 exec, s[64:65]
    ds_add_rtn_u32 v152, v149, v7 offset:1408
    s_mov_b64 exec, -1
    s_mov_b64 exec, 1
    ds_add_u32 v118, v7 offset:1292
    s_mov_b64 exec, -1
    v_lshlrev_b32 v120, 2, v0
    v_min_u32 v120, 124, v120
K2_QSQ1:
    ds_read_b32 v121, v118 offset:1292
    s_waitcnt lgkmcnt(0)
    v_readfirstlane_b32 s57, v121
    s_nop 0
    s_cmp_lt_u32 s57, 2
    s_nop 1
    s_cbranch_scc1 K2_QSQ1
    ds_read_b32 v80, v120 offset:1408
    s_waitcnt lgkmcnt(0)
    v_mov_b32 v14, v80
    s_nop 1
    v_add_u32_dpp v14, v14, v14 row_shr:1 row_mask:0xf bank_mask:0xf
    s_nop 1
    v_add_u32_dpp v14, v14, v14 row_shr:2 row_mask:0xf bank_mask:0xf
    s_nop 1
    v_add_u32_dpp v14, v14, v14 row_shr:4 row_mask:0xf bank_mask:0xf
    v_sub_u32 v80, v14, v80
    s_mov_b64 s[72:73], 0x7f
    v_cndmask_b32 v14, -1, v14, s[72:73]
    ds_bpermute_b32 v147, v147, v80
    ds_bpermute_b32 v148, v148, v80
    ds_bpermute_b32 v149, v149, v80
    s_waitcnt lgkmcnt(0)
    v_add_lshl_u32 v147, v147, v150, 1
    v_add_lshl_u32 v148, v148, v151, 1
    v_add_lshl_u32 v149, v149, v152, 1
    s_mov_b64 exec, s[60:61]
    ds_write_b16 v147, v137 offset:2560
    s_mov_b64 exec, s[62:63]
    ds_write_b16 v148, v138 offset:2560
    s_mov_b64 exec, s[64:65]
    ds_write_b16 v149, v139 offset:2560
    s_mov_b64 exec, 1
    ds_add_u32 v118, v7 offset:1296
    s_mov_b64 exec, -1
    s_lshl_b32 s64, s78, 16
    s_and_b32 s65, s78, 0xffff0000
    s_lshl_b32 s66, s79, 16
    s_and_b32 s67, s79, 0xffff0000
K2_MAIN:
    v_mov_b32 v24, 0
    v_mov_b32 v25, 0
    v_mov_b32 v26, 0
    v_mov_b32 v27, 0
    s_mov_b32 s38, 0x22221111
    s_mov_b32 s39, 0x88884444
    s_mov_b32 s77, 0
    v_mov_b32 v76, 0
    v_lshlrev_b32 v77, 2, v0
    v_min_u32 v77, 124, v77
K2_QSQ2:
    ds_read_b32 v78, v76 offset:1296
    s_waitcnt lgkmcnt(0)
    v_readfirstlane_b32 s57, v78
    s_nop 0
    s_cmp_lt_u32 s57, 2
    s_nop 1
    s_cbranch_scc1 K2_QSQ2
    ds_read_b32 v80, v77 offset:1408
    s_waitcnt lgkmcnt(0)
    v_mov_b32 v14, v80
    s_nop 1
    v_add_u32_dpp v14, v14, v14 row_shr:1 row_mask:0xf bank_mask:0xf
    s_nop 1
    v_add_u32_dpp v14, v14, v14 row_shr:2 row_mask:0xf bank_mask:0xf
    s_nop 1
    v_add_u32_dpp v14, v14, v14 row_shr:4 row_mask:0xf bank_mask:0xf
    v_sub_u32 v80, v14, v80
    s_mov_b64 s[72:73], 0x7f
    v_cndmask_b32 v14, -1, v14, s[72:73]
    s_cmp_lg_u32 s44, 0
    s_cbranch_scc1 K2_PRE
    v_mov_b32 v165, 0
    s_mov_b64 exec, 1
    ds_add_rtn_u32 v165, v165, v7 offset:1300
    s_mov_b64 exec, -1
    s_waitcnt lgkmcnt(0)
    v_readfirstlane_b32 s50, v165
    s_nop 0
    s_add_u32 s50, s50, s75
    s_cmp_lt_u32 s50, s9
    s_cselect_b32 s6, 1, 0
    s_cbranch_scc1 K2_NPHM
    s_sub_u32 s57, s50, s9
    s_lshl_b32 s57, s57, 2
    s_min_u32 s57, s57, 500
    v_cmp_ge_u32 vcc, s57, v14
    s_nop 0
    s_bcnt1_i32_b64 s72, vcc
    s_sub_u32 s52, 6, s72
    s_add_u32 s57, s57, 512
    v_lshl_add_u32 v13, s57, 1, v8
    s_nop 0
    s_branch K2_NPEM
K2_NPHM:
    s_lshl_b32 s57, s50, 2
    s_mov_b32 s52, 1
    v_add_u32 v13, s57, v164
K2_NPEM:
    ds_read_u16 v13, v13 offset:1536
    s_cmp_lg_u32 s53, 0
    s_cbranch_scc1 K2_SLOW
    s_call_b64 s[62:63], K2_ISS_A
    s_cmp_eq_u32 s44, 0
    s_cbranch_scc1 K2_ZERO
    buffer_load_dwordx4 v[116:119], v18, s[16:19], 0 offen offset:0
    buffer_load_dwordx4 v[120:123], v18, s[16:19], 0 offen offset:128
    buffer_load_dwordx4 v[124:127], v18, s[16:19], 0 offen offset:256
    buffer_load_dwordx4 v[128:131], v19, s[12:15], 0 offen offset:0
    buffer_load_dwordx4 v[132:135], v19, s[12:15], 0 offen offset:256
    buffer_load_dwordx4 v[136:139], v19, s[12:15], 0 offen offset:512
    s_call_b64 s[62:63], K2_ISS_B
    s_cmp_eq_u32 s45, 0
    s_cbranch_scc1 K2_FE3
    buffer_load_dwordx4 v[140:143], v18, s[16:19], 0 offen offset:0
    buffer_load_dwordx4 v[144:147], v18, s[16:19], 0 offen offset:128
    buffer_load_dwordx4 v[148:151], v18, s[16:19], 0 offen offset:256
    buffer_load_dwordx4 v[152:155], v19, s[12:15], 0 offen offset:0
    buffer_load_dwordx4 v[156:159], v19, s[12:15], 0 offen offset:256
    buffer_load_dwordx4 v[160:163], v19, s[12:15], 0 offen offset:512
K2_FE3:
K2_PRE:
    v_mov_b32 v76, 0
K2_FL:
    ds_read_b32 v77, v76 offset:1288
    s_waitcnt lgkmcnt(0)
    v_readfirstlane_b32 s57, v77
    s_nop 0
    s_cmp_lt_u32 s57, 10
    s_nop 1
    s_cbranch_scc0 K2_FH
    s_sleep 1
    s_branch K2_FL
K2_FH:
    ds_bpermute_b32 v15, v5, v20
    ds_bpermute_b32 v31, v10, v20
    ds_read_b96 v[28:30], v20 offset:13840
    ds_read_b128 v[32:35], v6 offset:7680
    ds_read_b128 v[36:39], v6 offset:8704
    ds_read_b128 v[40:43], v6 offset:9728
K2_LOOP:
    s_waitcnt lgkmcnt(0)
    s_mov_b64 exec, s[38:39]
    ds_read_b64 v[24:25], v15 offset:13824
    ds_read_b64 v[26:27], v31 offset:13824
    s_mov_b64 exec, -1
    s_mov_b32 s36, s40
    s_mov_b32 s37, s46
    s_mov_b32 s76, s4
    v_mov_b32 v16, v22
    s_nop 0
    s_call_b64 s[62:63], K2_ISS_A
    s_call_b64 s[60:61], K2_CMP_A
    s_mov_b32 s77, 0
    s_cmp_eq_u32 s37, 0
    s_cbranch_scc1 K2_SEA
    s_cmp_lg_u32 s76, 0
    s_cbranch_scc1 K2_SHA
    s_call_b64 s[60:61], K2_EPI
    buffer_store_dwordx4 v[44:47], v16, s[24:27], 0 offen sc1
    buffer_store_dwordx4 v[48:51], v16, s[24:27], 0 offen offset:512 sc1
    s_mov_b32 s77, 2
    s_branch K2_SEA
K2_SHA:
    s_call_b64 s[60:61], K2_EPH
    buffer_store_dwordx4 v[44:47], v16, s[24:27], 0 offen sc1
    s_mov_b32 s77, 1
K2_SEA:
    s_cmp_eq_u32 s45, 0
    s_cbranch_scc1 K2_ZERO
    s_waitcnt lgkmcnt(0)
    s_mov_b64 exec, s[38:39]
    ds_read_b64 v[24:25], v15 offset:13824
    ds_read_b64 v[26:27], v31 offset:13824
    s_mov_b64 exec, -1
    s_mov_b32 s36, s41
    s_mov_b32 s37, s47
    s_mov_b32 s76, s5
    v_mov_b32 v16, v23
    s_nop 0
    s_call_b64 s[62:63], K2_ISS_B
    s_call_b64 s[60:61], K2_CMP_B
    s_mov_b32 s77, 0
    s_cmp_eq_u32 s37, 0
    s_cbranch_scc1 K2_SEB
    s_cmp_lg_u32 s76, 0
    s_cbranch_scc1 K2_SHB
    s_call_b64 s[60:61], K2_EPI
    buffer_store_dwordx4 v[44:47], v16, s[24:27], 0 offen sc1
    buffer_store_dwordx4 v[48:51], v16, s[24:27], 0 offen offset:512 sc1
    s_mov_b32 s77, 2
    s_branch K2_SEB
K2_SHB:
    s_call_b64 s[60:61], K2_EPH
    buffer_store_dwordx4 v[44:47], v16, s[24:27], 0 offen sc1
    s_mov_b32 s77, 1
K2_SEB:
    s_cmp_lg_u32 s44, 0
    s_cbranch_scc1 K2_LOOP
K2_ZERO:
    s_cmp_lg_u32 s52, 0
    s_cbranch_scc1 K2_DONE
    s_waitcnt lgkmcnt(0)
    s_mov_b32 s7, s6
    v_add_u32 v12, s42, v13
    v_cmp_gt_u32 vcc, 313, v13
    s_nop 0
    s_mov_b64 s[72:73], vcc
    s_cmp_lg_u32 s6, 0
    s_cselect_b32 s8, 16, 8
    s_cbranch_scc1 K2_PSHZ
    v_lshl_add_u32 v11, v13, 7, v4
    v_lshl_add_u32 v12, v12, 10, v3
    s_nop 0
    s_branch K2_PSEZ
K2_PSHZ:
    v_lshlrev_b32 v17, 2, v13
    ds_read_b32 v17, v17 offset:0
    v_lshl_add_u32 v11, v13, 7, v167
    v_lshl_add_u32 v12, v12, 10, v166
    s_waitcnt lgkmcnt(0)
    v_readlane_b32 s51, v17, 0
    v_readlane_b32 s57, v17, 32
    s_nop 0
    s_max_u32 s51, s51, s57
    s_add_u32 s51, s51, 3
    s_lshr_b32 s51, s51, 2
    s_max_u32 s51, s51, 3
    s_min_u32 s51, s51, 8
K2_PSEZ:
    v_cndmask_b32 v12, v9, v12, s[72:73]
    v_mov_b32 v165, 0
    s_mov_b64 exec, 1
    ds_add_rtn_u32 v165, v165, v7 offset:1300
    s_mov_b64 exec, -1
    buffer_load_dwordx4 v[68:71], v12, s[12:15], 0 offen
    buffer_load_dwordx4 v[72:75], v12, s[12:15], 0 offen offset:512
    s_waitcnt lgkmcnt(0)
    v_readfirstlane_b32 s50, v165
    s_nop 0
    s_add_u32 s50, s50, s75
    s_cmp_lt_u32 s50, s9
    s_cselect_b32 s6, 1, 0
    s_cbranch_scc1 K2_NPHZ
    s_sub_u32 s57, s50, s9
    s_lshl_b32 s57, s57, 2
    s_min_u32 s57, s57, 500
    v_cmp_ge_u32 vcc, s57, v14
    s_nop 0
    s_bcnt1_i32_b64 s72, vcc
    s_sub_u32 s52, 6, s72
    s_add_u32 s57, s57, 512
    v_lshl_add_u32 v13, s57, 1, v8
    s_nop 0
    s_branch K2_NPEZ
K2_NPHZ:
    s_lshl_b32 s57, s50, 2
    s_mov_b32 s52, 1
    v_add_u32 v13, s57, v164
K2_NPEZ:
    ds_read_u16 v13, v13 offset:1536
    s_waitcnt vmcnt(0)
    buffer_store_dwordx4 v[68:71], v12, s[24:27], 0 offen sc1
    buffer_store_dwordx4 v[72:75], v12, s[24:27], 0 offen offset:512 sc1
    s_nop 0
    s_branch K2_ZERO
K2_DONE:
    s_endpgm
K2_ISS_A:
    s_mov_b32 s40, 0
    s_cmp_lg_u32 s51, 0
    s_cbranch_scc1 K2_IS3A
    s_waitcnt lgkmcnt(0)
    s_cmp_gt_i32 s52, 0
    s_cbranch_scc1 K2_IS0A
    s_mov_b32 s44, 0
    s_setpc_b64 s[62:63]
K2_IS0A:
    s_mov_b32 s51, s52
    s_mov_b32 s7, s6
    v_add_u32 v12, s42, v13
    v_cmp_gt_u32 vcc, 313, v13
    s_nop 0
    s_mov_b64 s[72:73], vcc
    s_cmp_lg_u32 s6, 0
    s_cselect_b32 s8, 16, 8
    s_cbranch_scc1 K2_PSHA
    v_lshl_add_u32 v11, v13, 7, v4
    v_lshl_add_u32 v12, v12, 10, v3
    s_nop 0
    s_branch K2_PSEA
K2_PSHA:
    v_lshlrev_b32 v17, 2, v13
    ds_read_b32 v17, v17 offset:0
    v_lshl_add_u32 v11, v13, 7, v167
    v_lshl_add_u32 v12, v12, 10, v166
    s_waitcnt lgkmcnt(0)
    v_readlane_b32 s51, v17, 0
    v_readlane_b32 s57, v17, 32
    s_nop 0
    s_max_u32 s51, s51, s57
    s_add_u32 s51, s51, 3
    s_lshr_b32 s51, s51, 2
    s_max_u32 s51, s51, 3
    s_min_u32 s51, s51, 8
K2_PSEA:
    v_cndmask_b32 v12, v9, v12, s[72:73]
    s_mov_b32 s40, 1
K2_IS3A:
    ds_read_b32 v17, v11 offset:46592
    s_mov_b32 s44, 3
    s_sub_u32 s51, s51, 1
    s_cmp_eq_u32 s51, 0
    s_cselect_b32 s46, 1, 0
    s_cbranch_scc1 K2_IS2A
    s_waitcnt lgkmcnt(0)
    v_and_b32 v19, 0x3fff, v17
    v_lshrrev_b32 v17, 14, v17
    v_mad_u32_u24 v18, v19, s74, v1
    v_lshl_add_u32 v19, v19, 10, v2
    v_lshlrev_b32 v20, 5, v17
    v_add_u32 v11, s8, v11
    s_nop 0
    s_setpc_b64 s[62:63]
K2_IS2A:
    v_mov_b32 v165, 0
    s_mov_b64 exec, 1
    ds_add_rtn_u32 v165, v165, v7 offset:1300
    s_mov_b64 exec, -1
    v_mov_b32 v22, v12
    s_mov_b32 s4, s7
    s_waitcnt lgkmcnt(0)
    v_readfirstlane_b32 s50, v165
    s_nop 0
    s_add_u32 s50, s50, s75
    v_and_b32 v19, 0x3fff, v17
    v_lshrrev_b32 v17, 14, v17
    v_mad_u32_u24 v18, v19, s74, v1
    v_lshl_add_u32 v19, v19, 10, v2
    v_lshlrev_b32 v20, 5, v17
    v_add_u32 v11, s8, v11
    s_cmp_lt_u32 s50, s9
    s_cselect_b32 s6, 1, 0
    s_cbranch_scc1 K2_NPHA
    s_sub_u32 s57, s50, s9
    s_lshl_b32 s57, s57, 2
    s_min_u32 s57, s57, 500
    v_cmp_ge_u32 vcc, s57, v14
    s_nop 0
    s_bcnt1_i32_b64 s72, vcc
    s_sub_u32 s52, 6, s72
    s_add_u32 s57, s57, 512
    v_lshl_add_u32 v13, s57, 1, v8
    s_nop 0
    s_branch K2_NPEA
K2_NPHA:
    s_lshl_b32 s57, s50, 2
    s_mov_b32 s52, 1
    v_add_u32 v13, s57, v164
K2_NPEA:
    ds_read_u16 v13, v13 offset:1536
    s_setpc_b64 s[62:63]
K2_CMP_A:
    v_mfma_f32_16x16x32_bf16 v[44:47], v[24:27], v[32:35], 0
    v_mfma_f32_16x16x32_bf16 v[48:51], v[24:27], v[36:39], 0
    v_mfma_f32_16x16x32_bf16 v[52:55], v[24:27], v[40:43], 0
    ds_read_b128 v[32:35], v6 offset:10752
    ds_read_b128 v[36:39], v6 offset:11776
    ds_read_b128 v[40:43], v6 offset:12800
    s_add_u32 s57, s77, s45
    s_cmp_eq_u32 s57, 3
    s_nop 1
    s_cbranch_scc1 K2_W0A
    s_cmp_eq_u32 s57, 5
    s_cbranch_scc1 K2_W4A
    s_cmp_eq_u32 s57, 4
    s_cbranch_scc1 K2_W2A
    s_waitcnt vmcnt(0)
    s_branch K2_W1A
K2_W4A:
    s_waitcnt vmcnt(8)
    s_branch K2_W1A
K2_W2A:
    s_waitcnt vmcnt(7)
    s_branch K2_W1A
K2_W0A:
    s_waitcnt vmcnt(6)
K2_W1A:
    s_cmp_eq_u32 s37, 0
    s_cbranch_scc1 K2_W3A
    buffer_load_dwordx4 v[68:71], v16, s[12:15], 0 offen
    s_cmp_lg_u32 s76, 0
    s_cbranch_scc1 K2_W3A
    buffer_load_dwordx4 v[72:75], v16, s[12:15], 0 offen offset:512
K2_W3A:
    s_cmp_eq_u32 s44, 0
    s_cbranch_scc1 K2_CTA
    s_cmp_lg_u32 s36, 0
    s_cbranch_scc1 K2_CFA
    v_lshlrev_b32_e64 v76, 16, v120
    v_and_b32 v77, 0xffff0000, v120
    v_pk_mul_f32 v[80:81], v[76:77], v[48:49]
    v_lshlrev_b32_e64 v78, 16, v121
    v_and_b32 v79, 0xffff0000, v121
    v_pk_mul_f32 v[82:83], v[78:79], v[50:51]
    v_lshlrev_b32_e64 v76, 16, v116
    v_and_b32 v77, 0xffff0000, v116
    v_pk_fma_f32 v[84:85], v[76:77], v[44:45], v[84:85]
    v_lshlrev_b32_e64 v78, 16, v117
    v_and_b32 v79, 0xffff0000, v117
    v_pk_fma_f32 v[86:87], v[78:79], v[46:47], v[86:87]
    s_waitcnt lgkmcnt(0)
    v_mfma_f32_16x16x32_bf16 v[56:59], v[24:27], v[32:35], 0
    v_mfma_f32_16x16x32_bf16 v[60:63], v[24:27], v[36:39], 0
    v_mfma_f32_16x16x32_bf16 v[64:67], v[24:27], v[40:43], 0
    v_mov_b32_e64 v32, v29
    v_lshlrev_b32_e64 v76, 16, v124
    v_and_b32 v77, 0xffff0000, v124
    v_pk_mul_f32 v[76:77], v[76:77], v[52:53]
    v_pk_fma_f32 v[92:93], v[76:77], v[28:29], v[92:93] op_sel:[0,0,0] op_sel_hi:[1,0,1]
    v_pk_fma_f32 v[100:101], v[76:77], v[32:33], v[100:101] op_sel:[0,0,0] op_sel_hi:[1,0,1]
    v_pk_fma_f32 v[108:109], v[76:77], v[30:31], v[108:109] op_sel:[0,0,0] op_sel_hi:[1,0,1]
    v_lshlrev_b32_e64 v78, 16, v125
    v_and_b32 v79, 0xffff0000, v125
    v_pk_mul_f32 v[78:79], v[78:79], v[54:55]
    v_pk_fma_f32 v[94:95], v[78:79], v[28:29], v[94:95] op_sel:[0,0,0] op_sel_hi:[1,0,1]
    v_pk_fma_f32 v[102:103], v[78:79], v[32:33], v[102:103] op_sel:[0,0,0] op_sel_hi:[1,0,1]
    v_pk_fma_f32 v[110:111], v[78:79], v[30:31], v[110:111] op_sel:[0,0,0] op_sel_hi:[1,0,1]
    v_lshlrev_b32_e64 v76, 16, v128
    v_and_b32 v77, 0xffff0000, v128
    v_pk_fma_f32 v[92:93], v[80:81], v[76:77], v[92:93]
    v_lshlrev_b32_e64 v78, 16, v129
    v_and_b32 v79, 0xffff0000, v129
    v_pk_fma_f32 v[94:95], v[82:83], v[78:79], v[94:95]
    v_lshlrev_b32_e64 v76, 16, v132
    v_and_b32 v77, 0xffff0000, v132
    v_pk_fma_f32 v[100:101], v[80:81], v[76:77], v[100:101]
    v_lshlrev_b32_e64 v78, 16, v133
    v_and_b32 v79, 0xffff0000, v133
    v_pk_fma_f32 v[102:103], v[82:83], v[78:79], v[102:103]
    v_lshlrev_b32_e64 v76, 16, v136
    v_and_b32 v77, 0xffff0000, v136
    v_pk_fma_f32 v[108:109], v[80:81], v[76:77], v[108:109]
    v_lshlrev_b32_e64 v78, 16, v137
    v_and_b32 v79, 0xffff0000, v137
    v_pk_fma_f32 v[110:111], v[82:83], v[78:79], v[110:111]
    v_lshlrev_b32_e64 v76, 16, v122
    v_and_b32 v77, 0xffff0000, v122
    v_pk_mul_f32 v[80:81], v[76:77], v[60:61]
    v_lshlrev_b32_e64 v78, 16, v123
    v_and_b32 v79, 0xffff0000, v123
    v_pk_mul_f32 v[82:83], v[78:79], v[62:63]
    buffer_load_dwordx4 v[120:123], v18, s[16:19], 0 offen offset:128
    v_lshlrev_b32_e64 v76, 16, v118
    v_and_b32 v77, 0xffff0000, v118
    v_pk_fma_f32 v[88:89], v[76:77], v[56:57], v[88:89]
    v_lshlrev_b32_e64 v78, 16, v119
    v_and_b32 v79, 0xffff0000, v119
    v_pk_fma_f32 v[90:91], v[78:79], v[58:59], v[90:91]
    buffer_load_dwordx4 v[116:119], v18, s[16:19], 0 offen offset:0
    v_lshlrev_b32_e64 v76, 16, v126
    v_and_b32 v77, 0xffff0000, v126
    v_pk_mul_f32 v[76:77], v[76:77], v[64:65]
    v_pk_fma_f32 v[96:97], v[76:77], v[28:29], v[96:97] op_sel:[0,0,0] op_sel_hi:[1,0,1]
    v_pk_fma_f32 v[104:105], v[76:77], v[32:33], v[104:105] op_sel:[0,0,0] op_sel_hi:[1,0,1]
    v_pk_fma_f32 v[112:113], v[76:77], v[30:31], v[112:113] op_sel:[0,0,0] op_sel_hi:[1,0,1]
    v_lshlrev_b32_e64 v78, 16, v127
    v_and_b32 v79, 0xffff0000, v127
    v_pk_mul_f32 v[78:79], v[78:79], v[66:67]
    buffer_load_dwordx4 v[124:127], v18, s[16:19], 0 offen offset:256
    v_pk_fma_f32 v[98:99], v[78:79], v[28:29], v[98:99] op_sel:[0,0,0] op_sel_hi:[1,0,1]
    v_pk_fma_f32 v[106:107], v[78:79], v[32:33], v[106:107] op_sel:[0,0,0] op_sel_hi:[1,0,1]
    v_pk_fma_f32 v[114:115], v[78:79], v[30:31], v[114:115] op_sel:[0,0,0] op_sel_hi:[1,0,1]
    ds_bpermute_b32 v15, v5, v21
    ds_bpermute_b32 v31, v10, v21
    ds_read_b96 v[28:30], v21 offset:13840
    ds_read_b128 v[32:35], v6 offset:7680
    ds_read_b128 v[36:39], v6 offset:8704
    ds_read_b128 v[40:43], v6 offset:9728
    v_lshlrev_b32_e64 v76, 16, v130
    v_and_b32 v77, 0xffff0000, v130
    v_pk_fma_f32 v[96:97], v[80:81], v[76:77], v[96:97]
    v_lshlrev_b32_e64 v78, 16, v131
    v_and_b32 v79, 0xffff0000, v131
    buffer_load_dwordx4 v[128:131], v19, s[12:15], 0 offen offset:0
    v_pk_fma_f32 v[98:99], v[82:83], v[78:79], v[98:99]
    v_lshlrev_b32_e64 v76, 16, v134
    v_and_b32 v77, 0xffff0000, v134
    v_pk_fma_f32 v[104:105], v[80:81], v[76:77], v[104:105]
    v_lshlrev_b32_e64 v78, 16, v135
    v_and_b32 v79, 0xffff0000, v135
    buffer_load_dwordx4 v[132:135], v19, s[12:15], 0 offen offset:256
    v_pk_fma_f32 v[106:107], v[82:83], v[78:79], v[106:107]
    v_lshlrev_b32_e64 v76, 16, v138
    v_and_b32 v77, 0xffff0000, v138
    v_pk_fma_f32 v[112:113], v[80:81], v[76:77], v[112:113]
    v_lshlrev_b32_e64 v78, 16, v139
    v_and_b32 v79, 0xffff0000, v139
    buffer_load_dwordx4 v[136:139], v19, s[12:15], 0 offen offset:512
    v_pk_fma_f32 v[114:115], v[82:83], v[78:79], v[114:115]
    s_nop 0
    s_setpc_b64 s[60:61]
K2_CFA:
    v_lshlrev_b32_e64 v76, 16, v120
    v_and_b32 v77, 0xffff0000, v120
    v_pk_mul_f32 v[80:81], v[76:77], v[48:49]
    v_lshlrev_b32_e64 v78, 16, v121
    v_and_b32 v79, 0xffff0000, v121
    v_pk_mul_f32 v[82:83], v[78:79], v[50:51]
    v_lshlrev_b32_e64 v76, 16, v116
    v_and_b32 v77, 0xffff0000, v116
    v_pk_mul_f32 v[84:85], v[76:77], v[44:45]
    v_lshlrev_b32_e64 v78, 16, v117
    v_and_b32 v79, 0xffff0000, v117
    v_pk_mul_f32 v[86:87], v[78:79], v[46:47]
    s_waitcnt lgkmcnt(0)
    v_mfma_f32_16x16x32_bf16 v[56:59], v[24:27], v[32:35], 0
    v_mfma_f32_16x16x32_bf16 v[60:63], v[24:27], v[36:39], 0
    v_mfma_f32_16x16x32_bf16 v[64:67], v[24:27], v[40:43], 0
    v_mov_b32_e64 v32, v29
    v_lshlrev_b32_e64 v76, 16, v124
    v_and_b32 v77, 0xffff0000, v124
    v_pk_mul_f32 v[76:77], v[76:77], v[52:53]
    v_pk_mul_f32 v[92:93], v[76:77], v[28:29] op_sel:[0,0] op_sel_hi:[1,0]
    v_pk_mul_f32 v[100:101], v[76:77], v[32:33] op_sel:[0,0] op_sel_hi:[1,0]
    v_pk_mul_f32 v[108:109], v[76:77], v[30:31] op_sel:[0,0] op_sel_hi:[1,0]
    v_lshlrev_b32_e64 v78, 16, v125
    v_and_b32 v79, 0xffff0000, v125
    v_pk_mul_f32 v[78:79], v[78:79], v[54:55]
    v_pk_mul_f32 v[94:95], v[78:79], v[28:29] op_sel:[0,0] op_sel_hi:[1,0]
    v_pk_mul_f32 v[102:103], v[78:79], v[32:33] op_sel:[0,0] op_sel_hi:[1,0]
    v_pk_mul_f32 v[110:111], v[78:79], v[30:31] op_sel:[0,0] op_sel_hi:[1,0]
    v_lshlrev_b32_e64 v76, 16, v128
    v_and_b32 v77, 0xffff0000, v128
    v_pk_fma_f32 v[92:93], v[80:81], v[76:77], v[92:93]
    v_lshlrev_b32_e64 v78, 16, v129
    v_and_b32 v79, 0xffff0000, v129
    v_pk_fma_f32 v[94:95], v[82:83], v[78:79], v[94:95]
    v_lshlrev_b32_e64 v76, 16, v132
    v_and_b32 v77, 0xffff0000, v132
    v_pk_fma_f32 v[100:101], v[80:81], v[76:77], v[100:101]
    v_lshlrev_b32_e64 v78, 16, v133
    v_and_b32 v79, 0xffff0000, v133
    v_pk_fma_f32 v[102:103], v[82:83], v[78:79], v[102:103]
    v_lshlrev_b32_e64 v76, 16, v136
    v_and_b32 v77, 0xffff0000, v136
    v_pk_fma_f32 v[108:109], v[80:81], v[76:77], v[108:109]
    v_lshlrev_b32_e64 v78, 16, v137
    v_and_b32 v79, 0xffff0000, v137
    v_pk_fma_f32 v[110:111], v[82:83], v[78:79], v[110:111]
    v_lshlrev_b32_e64 v76, 16, v122
    v_and_b32 v77, 0xffff0000, v122
    v_pk_mul_f32 v[80:81], v[76:77], v[60:61]
    v_lshlrev_b32_e64 v78, 16, v123
    v_and_b32 v79, 0xffff0000, v123
    v_pk_mul_f32 v[82:83], v[78:79], v[62:63]
    buffer_load_dwordx4 v[120:123], v18, s[16:19], 0 offen offset:128
    v_lshlrev_b32_e64 v76, 16, v118
    v_and_b32 v77, 0xffff0000, v118
    v_pk_mul_f32 v[88:89], v[76:77], v[56:57]
    v_lshlrev_b32_e64 v78, 16, v119
    v_and_b32 v79, 0xffff0000, v119
    v_pk_mul_f32 v[90:91], v[78:79], v[58:59]
    buffer_load_dwordx4 v[116:119], v18, s[16:19], 0 offen offset:0
    v_lshlrev_b32_e64 v76, 16, v126
    v_and_b32 v77, 0xffff0000, v126
    v_pk_mul_f32 v[76:77], v[76:77], v[64:65]
    v_pk_mul_f32 v[96:97], v[76:77], v[28:29] op_sel:[0,0] op_sel_hi:[1,0]
    v_pk_mul_f32 v[104:105], v[76:77], v[32:33] op_sel:[0,0] op_sel_hi:[1,0]
    v_pk_mul_f32 v[112:113], v[76:77], v[30:31] op_sel:[0,0] op_sel_hi:[1,0]
    v_lshlrev_b32_e64 v78, 16, v127
    v_and_b32 v79, 0xffff0000, v127
    v_pk_mul_f32 v[78:79], v[78:79], v[66:67]
    buffer_load_dwordx4 v[124:127], v18, s[16:19], 0 offen offset:256
    v_pk_mul_f32 v[98:99], v[78:79], v[28:29] op_sel:[0,0] op_sel_hi:[1,0]
    v_pk_mul_f32 v[106:107], v[78:79], v[32:33] op_sel:[0,0] op_sel_hi:[1,0]
    v_pk_mul_f32 v[114:115], v[78:79], v[30:31] op_sel:[0,0] op_sel_hi:[1,0]
    ds_bpermute_b32 v15, v5, v21
    ds_bpermute_b32 v31, v10, v21
    ds_read_b96 v[28:30], v21 offset:13840
    ds_read_b128 v[32:35], v6 offset:7680
    ds_read_b128 v[36:39], v6 offset:8704
    ds_read_b128 v[40:43], v6 offset:9728
    v_lshlrev_b32_e64 v76, 16, v130
    v_and_b32 v77, 0xffff0000, v130
    v_pk_fma_f32 v[96:97], v[80:81], v[76:77], v[96:97]
    v_lshlrev_b32_e64 v78, 16, v131
    v_and_b32 v79, 0xffff0000, v131
    buffer_load_dwordx4 v[128:131], v19, s[12:15], 0 offen offset:0
    v_pk_fma_f32 v[98:99], v[82:83], v[78:79], v[98:99]
    v_lshlrev_b32_e64 v76, 16, v134
    v_and_b32 v77, 0xffff0000, v134
    v_pk_fma_f32 v[104:105], v[80:81], v[76:77], v[104:105]
    v_lshlrev_b32_e64 v78, 16, v135
    v_and_b32 v79, 0xffff0000, v135
    buffer_load_dwordx4 v[132:135], v19, s[12:15], 0 offen offset:256
    v_pk_fma_f32 v[106:107], v[82:83], v[78:79], v[106:107]
    v_lshlrev_b32_e64 v76, 16, v138
    v_and_b32 v77, 0xffff0000, v138
    v_pk_fma_f32 v[112:113], v[80:81], v[76:77], v[112:113]
    v_lshlrev_b32_e64 v78, 16, v139
    v_and_b32 v79, 0xffff0000, v139
    buffer_load_dwordx4 v[136:139], v19, s[12:15], 0 offen offset:512
    v_pk_fma_f32 v[114:115], v[82:83], v[78:79], v[114:115]
    s_nop 0
    s_setpc_b64 s[60:61]
K2_CTA:
    s_cmp_lg_u32 s36, 0
    s_cbranch_scc1 K2_CFAT
    v_lshlrev_b32_e64 v76, 16, v120
    v_and_b32 v77, 0xffff0000, v120
    v_pk_mul_f32 v[80:81], v[76:77], v[48:49]
    v_lshlrev_b32_e64 v78, 16, v121
    v_and_b32 v79, 0xffff0000, v121
    v_pk_mul_f32 v[82:83], v[78:79], v[50:51]
    v_lshlrev_b32_e64 v76, 16, v116
    v_and_b32 v77, 0xffff0000, v116
    v_pk_fma_f32 v[84:85], v[76:77], v[44:45], v[84:85]
    v_lshlrev_b32_e64 v78, 16, v117
    v_and_b32 v79, 0xffff0000, v117
    v_pk_fma_f32 v[86:87], v[78:79], v[46:47], v[86:87]
    s_waitcnt lgkmcnt(0)
    v_mfma_f32_16x16x32_bf16 v[56:59], v[24:27], v[32:35], 0
    v_mfma_f32_16x16x32_bf16 v[60:63], v[24:27], v[36:39], 0
    v_mfma_f32_16x16x32_bf16 v[64:67], v[24:27], v[40:43], 0
    v_mov_b32_e64 v32, v29
    v_lshlrev_b32_e64 v76, 16, v124
    v_and_b32 v77, 0xffff0000, v124
    v_pk_mul_f32 v[76:77], v[76:77], v[52:53]
    v_pk_fma_f32 v[92:93], v[76:77], v[28:29], v[92:93] op_sel:[0,0,0] op_sel_hi:[1,0,1]
    v_pk_fma_f32 v[100:101], v[76:77], v[32:33], v[100:101] op_sel:[0,0,0] op_sel_hi:[1,0,1]
    v_pk_fma_f32 v[108:109], v[76:77], v[30:31], v[108:109] op_sel:[0,0,0] op_sel_hi:[1,0,1]
    v_lshlrev_b32_e64 v78, 16, v125
    v_and_b32 v79, 0xffff0000, v125
    v_pk_mul_f32 v[78:79], v[78:79], v[54:55]
    v_pk_fma_f32 v[94:95], v[78:79], v[28:29], v[94:95] op_sel:[0,0,0] op_sel_hi:[1,0,1]
    v_pk_fma_f32 v[102:103], v[78:79], v[32:33], v[102:103] op_sel:[0,0,0] op_sel_hi:[1,0,1]
    v_pk_fma_f32 v[110:111], v[78:79], v[30:31], v[110:111] op_sel:[0,0,0] op_sel_hi:[1,0,1]
    v_lshlrev_b32_e64 v76, 16, v128
    v_and_b32 v77, 0xffff0000, v128
    v_pk_fma_f32 v[92:93], v[80:81], v[76:77], v[92:93]
    v_lshlrev_b32_e64 v78, 16, v129
    v_and_b32 v79, 0xffff0000, v129
    v_pk_fma_f32 v[94:95], v[82:83], v[78:79], v[94:95]
    v_lshlrev_b32_e64 v76, 16, v132
    v_and_b32 v77, 0xffff0000, v132
    v_pk_fma_f32 v[100:101], v[80:81], v[76:77], v[100:101]
    v_lshlrev_b32_e64 v78, 16, v133
    v_and_b32 v79, 0xffff0000, v133
    v_pk_fma_f32 v[102:103], v[82:83], v[78:79], v[102:103]
    v_lshlrev_b32_e64 v76, 16, v136
    v_and_b32 v77, 0xffff0000, v136
    v_pk_fma_f32 v[108:109], v[80:81], v[76:77], v[108:109]
    v_lshlrev_b32_e64 v78, 16, v137
    v_and_b32 v79, 0xffff0000, v137
    v_pk_fma_f32 v[110:111], v[82:83], v[78:79], v[110:111]
    v_lshlrev_b32_e64 v76, 16, v122
    v_and_b32 v77, 0xffff0000, v122
    v_pk_mul_f32 v[80:81], v[76:77], v[60:61]
    v_lshlrev_b32_e64 v78, 16, v123
    v_and_b32 v79, 0xffff0000, v123
    v_pk_mul_f32 v[82:83], v[78:79], v[62:63]
    v_lshlrev_b32_e64 v76, 16, v118
    v_and_b32 v77, 0xffff0000, v118
    v_pk_fma_f32 v[88:89], v[76:77], v[56:57], v[88:89]
    v_lshlrev_b32_e64 v78, 16, v119
    v_and_b32 v79, 0xffff0000, v119
    v_pk_fma_f32 v[90:91], v[78:79], v[58:59], v[90:91]
    v_lshlrev_b32_e64 v76, 16, v126
    v_and_b32 v77, 0xffff0000, v126
    v_pk_mul_f32 v[76:77], v[76:77], v[64:65]
    v_pk_fma_f32 v[96:97], v[76:77], v[28:29], v[96:97] op_sel:[0,0,0] op_sel_hi:[1,0,1]
    v_pk_fma_f32 v[104:105], v[76:77], v[32:33], v[104:105] op_sel:[0,0,0] op_sel_hi:[1,0,1]
    v_pk_fma_f32 v[112:113], v[76:77], v[30:31], v[112:113] op_sel:[0,0,0] op_sel_hi:[1,0,1]
    v_lshlrev_b32_e64 v78, 16, v127
    v_and_b32 v79, 0xffff0000, v127
    v_pk_mul_f32 v[78:79], v[78:79], v[66:67]
    v_pk_fma_f32 v[98:99], v[78:79], v[28:29], v[98:99] op_sel:[0,0,0] op_sel_hi:[1,0,1]
    v_pk_fma_f32 v[106:107], v[78:79], v[32:33], v[106:107] op_sel:[0,0,0] op_sel_hi:[1,0,1]
    v_pk_fma_f32 v[114:115], v[78:79], v[30:31], v[114:115] op_sel:[0,0,0] op_sel_hi:[1,0,1]
    ds_bpermute_b32 v15, v5, v21
    ds_bpermute_b32 v31, v10, v21
    ds_read_b96 v[28:30], v21 offset:13840
    ds_read_b128 v[32:35], v6 offset:7680
    ds_read_b128 v[36:39], v6 offset:8704
    ds_read_b128 v[40:43], v6 offset:9728
    v_lshlrev_b32_e64 v76, 16, v130
    v_and_b32 v77, 0xffff0000, v130
    v_pk_fma_f32 v[96:97], v[80:81], v[76:77], v[96:97]
    v_lshlrev_b32_e64 v78, 16, v131
    v_and_b32 v79, 0xffff0000, v131
    v_pk_fma_f32 v[98:99], v[82:83], v[78:79], v[98:99]
    v_lshlrev_b32_e64 v76, 16, v134
    v_and_b32 v77, 0xffff0000, v134
    v_pk_fma_f32 v[104:105], v[80:81], v[76:77], v[104:105]
    v_lshlrev_b32_e64 v78, 16, v135
    v_and_b32 v79, 0xffff0000, v135
    v_pk_fma_f32 v[106:107], v[82:83], v[78:79], v[106:107]
    v_lshlrev_b32_e64 v76, 16, v138
    v_and_b32 v77, 0xffff0000, v138
    v_pk_fma_f32 v[112:113], v[80:81], v[76:77], v[112:113]
    v_lshlrev_b32_e64 v78, 16, v139
    v_and_b32 v79, 0xffff0000, v139
    v_pk_fma_f32 v[114:115], v[82:83], v[78:79], v[114:115]
    s_waitcnt vmcnt(0)
    s_setpc_b64 s[60:61]
K2_CFAT:
    v_lshlrev_b32_e64 v76, 16, v120
    v_and_b32 v77, 0xffff0000, v120
    v_pk_mul_f32 v[80:81], v[76:77], v[48:49]
    v_lshlrev_b32_e64 v78, 16, v121
    v_and_b32 v79, 0xffff0000, v121
    v_pk_mul_f32 v[82:83], v[78:79], v[50:51]
    v_lshlrev_b32_e64 v76, 16, v116
    v_and_b32 v77, 0xffff0000, v116
    v_pk_mul_f32 v[84:85], v[76:77], v[44:45]
    v_lshlrev_b32_e64 v78, 16, v117
    v_and_b32 v79, 0xffff0000, v117
    v_pk_mul_f32 v[86:87], v[78:79], v[46:47]
    s_waitcnt lgkmcnt(0)
    v_mfma_f32_16x16x32_bf16 v[56:59], v[24:27], v[32:35], 0
    v_mfma_f32_16x16x32_bf16 v[60:63], v[24:27], v[36:39], 0
    v_mfma_f32_16x16x32_bf16 v[64:67], v[24:27], v[40:43], 0
    v_mov_b32_e64 v32, v29
    v_lshlrev_b32_e64 v76, 16, v124
    v_and_b32 v77, 0xffff0000, v124
    v_pk_mul_f32 v[76:77], v[76:77], v[52:53]
    v_pk_mul_f32 v[92:93], v[76:77], v[28:29] op_sel:[0,0] op_sel_hi:[1,0]
    v_pk_mul_f32 v[100:101], v[76:77], v[32:33] op_sel:[0,0] op_sel_hi:[1,0]
    v_pk_mul_f32 v[108:109], v[76:77], v[30:31] op_sel:[0,0] op_sel_hi:[1,0]
    v_lshlrev_b32_e64 v78, 16, v125
    v_and_b32 v79, 0xffff0000, v125
    v_pk_mul_f32 v[78:79], v[78:79], v[54:55]
    v_pk_mul_f32 v[94:95], v[78:79], v[28:29] op_sel:[0,0] op_sel_hi:[1,0]
    v_pk_mul_f32 v[102:103], v[78:79], v[32:33] op_sel:[0,0] op_sel_hi:[1,0]
    v_pk_mul_f32 v[110:111], v[78:79], v[30:31] op_sel:[0,0] op_sel_hi:[1,0]
    v_lshlrev_b32_e64 v76, 16, v128
    v_and_b32 v77, 0xffff0000, v128
    v_pk_fma_f32 v[92:93], v[80:81], v[76:77], v[92:93]
    v_lshlrev_b32_e64 v78, 16, v129
    v_and_b32 v79, 0xffff0000, v129
    v_pk_fma_f32 v[94:95], v[82:83], v[78:79], v[94:95]
    v_lshlrev_b32_e64 v76, 16, v132
    v_and_b32 v77, 0xffff0000, v132
    v_pk_fma_f32 v[100:101], v[80:81], v[76:77], v[100:101]
    v_lshlrev_b32_e64 v78, 16, v133
    v_and_b32 v79, 0xffff0000, v133
    v_pk_fma_f32 v[102:103], v[82:83], v[78:79], v[102:103]
    v_lshlrev_b32_e64 v76, 16, v136
    v_and_b32 v77, 0xffff0000, v136
    v_pk_fma_f32 v[108:109], v[80:81], v[76:77], v[108:109]
    v_lshlrev_b32_e64 v78, 16, v137
    v_and_b32 v79, 0xffff0000, v137
    v_pk_fma_f32 v[110:111], v[82:83], v[78:79], v[110:111]
    v_lshlrev_b32_e64 v76, 16, v122
    v_and_b32 v77, 0xffff0000, v122
    v_pk_mul_f32 v[80:81], v[76:77], v[60:61]
    v_lshlrev_b32_e64 v78, 16, v123
    v_and_b32 v79, 0xffff0000, v123
    v_pk_mul_f32 v[82:83], v[78:79], v[62:63]
    v_lshlrev_b32_e64 v76, 16, v118
    v_and_b32 v77, 0xffff0000, v118
    v_pk_mul_f32 v[88:89], v[76:77], v[56:57]
    v_lshlrev_b32_e64 v78, 16, v119
    v_and_b32 v79, 0xffff0000, v119
    v_pk_mul_f32 v[90:91], v[78:79], v[58:59]
    v_lshlrev_b32_e64 v76, 16, v126
    v_and_b32 v77, 0xffff0000, v126
    v_pk_mul_f32 v[76:77], v[76:77], v[64:65]
    v_pk_mul_f32 v[96:97], v[76:77], v[28:29] op_sel:[0,0] op_sel_hi:[1,0]
    v_pk_mul_f32 v[104:105], v[76:77], v[32:33] op_sel:[0,0] op_sel_hi:[1,0]
    v_pk_mul_f32 v[112:113], v[76:77], v[30:31] op_sel:[0,0] op_sel_hi:[1,0]
    v_lshlrev_b32_e64 v78, 16, v127
    v_and_b32 v79, 0xffff0000, v127
    v_pk_mul_f32 v[78:79], v[78:79], v[66:67]
    v_pk_mul_f32 v[98:99], v[78:79], v[28:29] op_sel:[0,0] op_sel_hi:[1,0]
    v_pk_mul_f32 v[106:107], v[78:79], v[32:33] op_sel:[0,0] op_sel_hi:[1,0]
    v_pk_mul_f32 v[114:115], v[78:79], v[30:31] op_sel:[0,0] op_sel_hi:[1,0]
    ds_bpermute_b32 v15, v5, v21
    ds_bpermute_b32 v31, v10, v21
    ds_read_b96 v[28:30], v21 offset:13840
    ds_read_b128 v[32:35], v6 offset:7680
    ds_read_b128 v[36:39], v6 offset:8704
    ds_read_b128 v[40:43], v6 offset:9728
    v_lshlrev_b32_e64 v76, 16, v130
    v_and_b32 v77, 0xffff0000, v130
    v_pk_fma_f32 v[96:97], v[80:81], v[76:77], v[96:97]
    v_lshlrev_b32_e64 v78, 16, v131
    v_and_b32 v79, 0xffff0000, v131
    v_pk_fma_f32 v[98:99], v[82:83], v[78:79], v[98:99]
    v_lshlrev_b32_e64 v76, 16, v134
    v_and_b32 v77, 0xffff0000, v134
    v_pk_fma_f32 v[104:105], v[80:81], v[76:77], v[104:105]
    v_lshlrev_b32_e64 v78, 16, v135
    v_and_b32 v79, 0xffff0000, v135
    v_pk_fma_f32 v[106:107], v[82:83], v[78:79], v[106:107]
    v_lshlrev_b32_e64 v76, 16, v138
    v_and_b32 v77, 0xffff0000, v138
    v_pk_fma_f32 v[112:113], v[80:81], v[76:77], v[112:113]
    v_lshlrev_b32_e64 v78, 16, v139
    v_and_b32 v79, 0xffff0000, v139
    v_pk_fma_f32 v[114:115], v[82:83], v[78:79], v[114:115]
    s_waitcnt vmcnt(0)
    s_setpc_b64 s[60:61]
K2_ISS_B:
    s_mov_b32 s41, 0
    s_cmp_lg_u32 s51, 0
    s_cbranch_scc1 K2_IS3B
    s_waitcnt lgkmcnt(0)
    s_cmp_gt_i32 s52, 0
    s_cbranch_scc1 K2_IS0B
    s_mov_b32 s45, 0
    s_setpc_b64 s[62:63]
K2_IS0B:
    s_mov_b32 s51, s52
    s_mov_b32 s7, s6
    v_add_u32 v12, s42, v13
    v_cmp_gt_u32 vcc, 313, v13
    s_nop 0
    s_mov_b64 s[72:73], vcc
    s_cmp_lg_u32 s6, 0
    s_cselect_b32 s8, 16, 8
    s_cbranch_scc1 K2_PSHB
    v_lshl_add_u32 v11, v13, 7, v4
    v_lshl_add_u32 v12, v12, 10, v3
    s_nop 0
    s_branch K2_PSEB
K2_PSHB:
    v_lshlrev_b32 v17, 2, v13
    ds_read_b32 v17, v17 offset:0
    v_lshl_add_u32 v11, v13, 7, v167
    v_lshl_add_u32 v12, v12, 10, v166
    s_waitcnt lgkmcnt(0)
    v_readlane_b32 s51, v17, 0
    v_readlane_b32 s57, v17, 32
    s_nop 0
    s_max_u32 s51, s51, s57
    s_add_u32 s51, s51, 3
    s_lshr_b32 s51, s51, 2
    s_max_u32 s51, s51, 3
    s_min_u32 s51, s51, 8
K2_PSEB:
    v_cndmask_b32 v12, v9, v12, s[72:73]
    s_mov_b32 s41, 1
K2_IS3B:
    ds_read_b32 v17, v11 offset:46592
    s_mov_b32 s45, 3
    s_sub_u32 s51, s51, 1
    s_cmp_eq_u32 s51, 0
    s_cselect_b32 s47, 1, 0
    s_cbranch_scc1 K2_IS2B
    s_waitcnt lgkmcnt(0)
    v_and_b32 v19, 0x3fff, v17
    v_lshrrev_b32 v17, 14, v17
    v_mad_u32_u24 v18, v19, s74, v1
    v_lshl_add_u32 v19, v19, 10, v2
    v_lshlrev_b32 v21, 5, v17
    v_add_u32 v11, s8, v11
    s_nop 0
    s_setpc_b64 s[62:63]
K2_IS2B:
    v_mov_b32 v165, 0
    s_mov_b64 exec, 1
    ds_add_rtn_u32 v165, v165, v7 offset:1300
    s_mov_b64 exec, -1
    v_mov_b32 v23, v12
    s_mov_b32 s5, s7
    s_waitcnt lgkmcnt(0)
    v_readfirstlane_b32 s50, v165
    s_nop 0
    s_add_u32 s50, s50, s75
    v_and_b32 v19, 0x3fff, v17
    v_lshrrev_b32 v17, 14, v17
    v_mad_u32_u24 v18, v19, s74, v1
    v_lshl_add_u32 v19, v19, 10, v2
    v_lshlrev_b32 v21, 5, v17
    v_add_u32 v11, s8, v11
    s_cmp_lt_u32 s50, s9
    s_cselect_b32 s6, 1, 0
    s_cbranch_scc1 K2_NPHB
    s_sub_u32 s57, s50, s9
    s_lshl_b32 s57, s57, 2
    s_min_u32 s57, s57, 500
    v_cmp_ge_u32 vcc, s57, v14
    s_nop 0
    s_bcnt1_i32_b64 s72, vcc
    s_sub_u32 s52, 6, s72
    s_add_u32 s57, s57, 512
    v_lshl_add_u32 v13, s57, 1, v8
    s_nop 0
    s_branch K2_NPEB
K2_NPHB:
    s_lshl_b32 s57, s50, 2
    s_mov_b32 s52, 1
    v_add_u32 v13, s57, v164
K2_NPEB:
    ds_read_u16 v13, v13 offset:1536
    s_setpc_b64 s[62:63]
K2_CMP_B:
    v_mfma_f32_16x16x32_bf16 v[44:47], v[24:27], v[32:35], 0
    v_mfma_f32_16x16x32_bf16 v[48:51], v[24:27], v[36:39], 0
    v_mfma_f32_16x16x32_bf16 v[52:55], v[24:27], v[40:43], 0
    ds_read_b128 v[32:35], v6 offset:10752
    ds_read_b128 v[36:39], v6 offset:11776
    ds_read_b128 v[40:43], v6 offset:12800
    s_add_u32 s57, s77, s44
    s_cmp_eq_u32 s57, 3
    s_nop 1
    s_cbranch_scc1 K2_W0B
    s_cmp_eq_u32 s57, 5
    s_cbranch_scc1 K2_W4B
    s_cmp_eq_u32 s57, 4
    s_cbranch_scc1 K2_W2B
    s_waitcnt vmcnt(0)
    s_branch K2_W1B
K2_W4B:
    s_waitcnt vmcnt(8)
    s_branch K2_W1B
K2_W2B:
    s_waitcnt vmcnt(7)
    s_branch K2_W1B
K2_W0B:
    s_waitcnt vmcnt(6)
K2_W1B:
    s_cmp_eq_u32 s37, 0
    s_cbranch_scc1 K2_W3B
    buffer_load_dwordx4 v[68:71], v16, s[12:15], 0 offen
    s_cmp_lg_u32 s76, 0
    s_cbranch_scc1 K2_W3B
    buffer_load_dwordx4 v[72:75], v16, s[12:15], 0 offen offset:512
K2_W3B:
    s_cmp_eq_u32 s45, 0
    s_cbranch_scc1 K2_CTB
    s_cmp_lg_u32 s36, 0
    s_cbranch_scc1 K2_CFB
    v_lshlrev_b32_e64 v76, 16, v144
    v_and_b32 v77, 0xffff0000, v144
    v_pk_mul_f32 v[80:81], v[76:77], v[48:49]
    v_lshlrev_b32_e64 v78, 16, v145
    v_and_b32 v79, 0xffff0000, v145
    v_pk_mul_f32 v[82:83], v[78:79], v[50:51]
    v_lshlrev_b32_e64 v76, 16, v140
    v_and_b32 v77, 0xffff0000, v140
    v_pk_fma_f32 v[84:85], v[76:77], v[44:45], v[84:85]
    v_lshlrev_b32_e64 v78, 16, v141
    v_and_b32 v79, 0xffff0000, v141
    v_pk_fma_f32 v[86:87], v[78:79], v[46:47], v[86:87]
    s_waitcnt lgkmcnt(0)
    v_mfma_f32_16x16x32_bf16 v[56:59], v[24:27], v[32:35], 0
    v_mfma_f32_16x16x32_bf16 v[60:63], v[24:27], v[36:39], 0
    v_mfma_f32_16x16x32_bf16 v[64:67], v[24:27], v[40:43], 0
    v_mov_b32_e64 v32, v29
    v_lshlrev_b32_e64 v76, 16, v148
    v_and_b32 v77, 0xffff0000, v148
    v_pk_mul_f32 v[76:77], v[76:77], v[52:53]
    v_pk_fma_f32 v[92:93], v[76:77], v[28:29], v[92:93] op_sel:[0,0,0] op_sel_hi:[1,0,1]
    v_pk_fma_f32 v[100:101], v[76:77], v[32:33], v[100:101] op_sel:[0,0,0] op_sel_hi:[1,0,1]
    v_pk_fma_f32 v[108:109], v[76:77], v[30:31], v[108:109] op_sel:[0,0,0] op_sel_hi:[1,0,1]
    v_lshlrev_b32_e64 v78, 16, v149
    v_and_b32 v79, 0xffff0000, v149
    v_pk_mul_f32 v[78:79], v[78:79], v[54:55]
    v_pk_fma_f32 v[94:95], v[78:79], v[28:29], v[94:95] op_sel:[0,0,0] op_sel_hi:[1,0,1]
    v_pk_fma_f32 v[102:103], v[78:79], v[32:33], v[102:103] op_sel:[0,0,0] op_sel_hi:[1,0,1]
    v_pk_fma_f32 v[110:111], v[78:79], v[30:31], v[110:111] op_sel:[0,0,0] op_sel_hi:[1,0,1]
    v_lshlrev_b32_e64 v76, 16, v152
    v_and_b32 v77, 0xffff0000, v152
    v_pk_fma_f32 v[92:93], v[80:81], v[76:77], v[92:93]
    v_lshlrev_b32_e64 v78, 16, v153
    v_and_b32 v79, 0xffff0000, v153
    v_pk_fma_f32 v[94:95], v[82:83], v[78:79], v[94:95]
    v_lshlrev_b32_e64 v76, 16, v156
    v_and_b32 v77, 0xffff0000, v156
    v_pk_fma_f32 v[100:101], v[80:81], v[76:77], v[100:101]
    v_lshlrev_b32_e64 v78, 16, v157
    v_and_b32 v79, 0xffff0000, v157
    v_pk_fma_f32 v[102:103], v[82:83], v[78:79], v[102:103]
    v_lshlrev_b32_e64 v76, 16, v160
    v_and_b32 v77, 0xffff0000, v160
    v_pk_fma_f32 v[108:109], v[80:81], v[76:77], v[108:109]
    v_lshlrev_b32_e64 v78, 16, v161
    v_and_b32 v79, 0xffff0000, v161
    v_pk_fma_f32 v[110:111], v[82:83], v[78:79], v[110:111]
    v_lshlrev_b32_e64 v76, 16, v146
    v_and_b32 v77, 0xffff0000, v146
    v_pk_mul_f32 v[80:81], v[76:77], v[60:61]
    v_lshlrev_b32_e64 v78, 16, v147
    v_and_b32 v79, 0xffff0000, v147
    v_pk_mul_f32 v[82:83], v[78:79], v[62:63]
    buffer_load_dwordx4 v[144:147], v18, s[16:19], 0 offen offset:128
    v_lshlrev_b32_e64 v76, 16, v142
    v_and_b32 v77, 0xffff0000, v142
    v_pk_fma_f32 v[88:89], v[76:77], v[56:57], v[88:89]
    v_lshlrev_b32_e64 v78, 16, v143
    v_and_b32 v79, 0xffff0000, v143
    v_pk_fma_f32 v[90:91], v[78:79], v[58:59], v[90:91]
    buffer_load_dwordx4 v[140:143], v18, s[16:19], 0 offen offset:0
    v_lshlrev_b32_e64 v76, 16, v150
    v_and_b32 v77, 0xffff0000, v150
    v_pk_mul_f32 v[76:77], v[76:77], v[64:65]
    v_pk_fma_f32 v[96:97], v[76:77], v[28:29], v[96:97] op_sel:[0,0,0] op_sel_hi:[1,0,1]
    v_pk_fma_f32 v[104:105], v[76:77], v[32:33], v[104:105] op_sel:[0,0,0] op_sel_hi:[1,0,1]
    v_pk_fma_f32 v[112:113], v[76:77], v[30:31], v[112:113] op_sel:[0,0,0] op_sel_hi:[1,0,1]
    v_lshlrev_b32_e64 v78, 16, v151
    v_and_b32 v79, 0xffff0000, v151
    v_pk_mul_f32 v[78:79], v[78:79], v[66:67]
    buffer_load_dwordx4 v[148:151], v18, s[16:19], 0 offen offset:256
    v_pk_fma_f32 v[98:99], v[78:79], v[28:29], v[98:99] op_sel:[0,0,0] op_sel_hi:[1,0,1]
    v_pk_fma_f32 v[106:107], v[78:79], v[32:33], v[106:107] op_sel:[0,0,0] op_sel_hi:[1,0,1]
    v_pk_fma_f32 v[114:115], v[78:79], v[30:31], v[114:115] op_sel:[0,0,0] op_sel_hi:[1,0,1]
    ds_bpermute_b32 v15, v5, v20
    ds_bpermute_b32 v31, v10, v20
    ds_read_b96 v[28:30], v20 offset:13840
    ds_read_b128 v[32:35], v6 offset:7680
    ds_read_b128 v[36:39], v6 offset:8704
    ds_read_b128 v[40:43], v6 offset:9728
    v_lshlrev_b32_e64 v76, 16, v154
    v_and_b32 v77, 0xffff0000, v154
    v_pk_fma_f32 v[96:97], v[80:81], v[76:77], v[96:97]
    v_lshlrev_b32_e64 v78, 16, v155
    v_and_b32 v79, 0xffff0000, v155
    buffer_load_dwordx4 v[152:155], v19, s[12:15], 0 offen offset:0
    v_pk_fma_f32 v[98:99], v[82:83], v[78:79], v[98:99]
    v_lshlrev_b32_e64 v76, 16, v158
    v_and_b32 v77, 0xffff0000, v158
    v_pk_fma_f32 v[104:105], v[80:81], v[76:77], v[104:105]
    v_lshlrev_b32_e64 v78, 16, v159
    v_and_b32 v79, 0xffff0000, v159
    buffer_load_dwordx4 v[156:159], v19, s[12:15], 0 offen offset:256
    v_pk_fma_f32 v[106:107], v[82:83], v[78:79], v[106:107]
    v_lshlrev_b32_e64 v76, 16, v162
    v_and_b32 v77, 0xffff0000, v162
    v_pk_fma_f32 v[112:113], v[80:81], v[76:77], v[112:113]
    v_lshlrev_b32_e64 v78, 16, v163
    v_and_b32 v79, 0xffff0000, v163
    buffer_load_dwordx4 v[160:163], v19, s[12:15], 0 offen offset:512
    v_pk_fma_f32 v[114:115], v[82:83], v[78:79], v[114:115]
    s_nop 0
    s_setpc_b64 s[60:61]
K2_CFB:
    v_lshlrev_b32_e64 v76, 16, v144
    v_and_b32 v77, 0xffff0000, v144
    v_pk_mul_f32 v[80:81], v[76:77], v[48:49]
    v_lshlrev_b32_e64 v78, 16, v145
    v_and_b32 v79, 0xffff0000, v145
    v_pk_mul_f32 v[82:83], v[78:79], v[50:51]
    v_lshlrev_b32_e64 v76, 16, v140
    v_and_b32 v77, 0xffff0000, v140
    v_pk_mul_f32 v[84:85], v[76:77], v[44:45]
    v_lshlrev_b32_e64 v78, 16, v141
    v_and_b32 v79, 0xffff0000, v141
    v_pk_mul_f32 v[86:87], v[78:79], v[46:47]
    s_waitcnt lgkmcnt(0)
    v_mfma_f32_16x16x32_bf16 v[56:59], v[24:27], v[32:35], 0
    v_mfma_f32_16x16x32_bf16 v[60:63], v[24:27], v[36:39], 0
    v_mfma_f32_16x16x32_bf16 v[64:67], v[24:27], v[40:43], 0
    v_mov_b32_e64 v32, v29
    v_lshlrev_b32_e64 v76, 16, v148
    v_and_b32 v77, 0xffff0000, v148
    v_pk_mul_f32 v[76:77], v[76:77], v[52:53]
    v_pk_mul_f32 v[92:93], v[76:77], v[28:29] op_sel:[0,0] op_sel_hi:[1,0]
    v_pk_mul_f32 v[100:101], v[76:77], v[32:33] op_sel:[0,0] op_sel_hi:[1,0]
    v_pk_mul_f32 v[108:109], v[76:77], v[30:31] op_sel:[0,0] op_sel_hi:[1,0]
    v_lshlrev_b32_e64 v78, 16, v149
    v_and_b32 v79, 0xffff0000, v149
    v_pk_mul_f32 v[78:79], v[78:79], v[54:55]
    v_pk_mul_f32 v[94:95], v[78:79], v[28:29] op_sel:[0,0] op_sel_hi:[1,0]
    v_pk_mul_f32 v[102:103], v[78:79], v[32:33] op_sel:[0,0] op_sel_hi:[1,0]
    v_pk_mul_f32 v[110:111], v[78:79], v[30:31] op_sel:[0,0] op_sel_hi:[1,0]
    v_lshlrev_b32_e64 v76, 16, v152
    v_and_b32 v77, 0xffff0000, v152
    v_pk_fma_f32 v[92:93], v[80:81], v[76:77], v[92:93]
    v_lshlrev_b32_e64 v78, 16, v153
    v_and_b32 v79, 0xffff0000, v153
    v_pk_fma_f32 v[94:95], v[82:83], v[78:79], v[94:95]
    v_lshlrev_b32_e64 v76, 16, v156
    v_and_b32 v77, 0xffff0000, v156
    v_pk_fma_f32 v[100:101], v[80:81], v[76:77], v[100:101]
    v_lshlrev_b32_e64 v78, 16, v157
    v_and_b32 v79, 0xffff0000, v157
    v_pk_fma_f32 v[102:103], v[82:83], v[78:79], v[102:103]
    v_lshlrev_b32_e64 v76, 16, v160
    v_and_b32 v77, 0xffff0000, v160
    v_pk_fma_f32 v[108:109], v[80:81], v[76:77], v[108:109]
    v_lshlrev_b32_e64 v78, 16, v161
    v_and_b32 v79, 0xffff0000, v161
    v_pk_fma_f32 v[110:111], v[82:83], v[78:79], v[110:111]
    v_lshlrev_b32_e64 v76, 16, v146
    v_and_b32 v77, 0xffff0000, v146
    v_pk_mul_f32 v[80:81], v[76:77], v[60:61]
    v_lshlrev_b32_e64 v78, 16, v147
    v_and_b32 v79, 0xffff0000, v147
    v_pk_mul_f32 v[82:83], v[78:79], v[62:63]
    buffer_load_dwordx4 v[144:147], v18, s[16:19], 0 offen offset:128
    v_lshlrev_b32_e64 v76, 16, v142
    v_and_b32 v77, 0xffff0000, v142
    v_pk_mul_f32 v[88:89], v[76:77], v[56:57]
    v_lshlrev_b32_e64 v78, 16, v143
    v_and_b32 v79, 0xffff0000, v143
    v_pk_mul_f32 v[90:91], v[78:79], v[58:59]
    buffer_load_dwordx4 v[140:143], v18, s[16:19], 0 offen offset:0
    v_lshlrev_b32_e64 v76, 16, v150
    v_and_b32 v77, 0xffff0000, v150
    v_pk_mul_f32 v[76:77], v[76:77], v[64:65]
    v_pk_mul_f32 v[96:97], v[76:77], v[28:29] op_sel:[0,0] op_sel_hi:[1,0]
    v_pk_mul_f32 v[104:105], v[76:77], v[32:33] op_sel:[0,0] op_sel_hi:[1,0]
    v_pk_mul_f32 v[112:113], v[76:77], v[30:31] op_sel:[0,0] op_sel_hi:[1,0]
    v_lshlrev_b32_e64 v78, 16, v151
    v_and_b32 v79, 0xffff0000, v151
    v_pk_mul_f32 v[78:79], v[78:79], v[66:67]
    buffer_load_dwordx4 v[148:151], v18, s[16:19], 0 offen offset:256
    v_pk_mul_f32 v[98:99], v[78:79], v[28:29] op_sel:[0,0] op_sel_hi:[1,0]
    v_pk_mul_f32 v[106:107], v[78:79], v[32:33] op_sel:[0,0] op_sel_hi:[1,0]
    v_pk_mul_f32 v[114:115], v[78:79], v[30:31] op_sel:[0,0] op_sel_hi:[1,0]
    ds_bpermute_b32 v15, v5, v20
    ds_bpermute_b32 v31, v10, v20
    ds_read_b96 v[28:30], v20 offset:13840
    ds_read_b128 v[32:35], v6 offset:7680
    ds_read_b128 v[36:39], v6 offset:8704
    ds_read_b128 v[40:43], v6 offset:9728
    v_lshlrev_b32_e64 v76, 16, v154
    v_and_b32 v77, 0xffff0000, v154
    v_pk_fma_f32 v[96:97], v[80:81], v[76:77], v[96:97]
    v_lshlrev_b32_e64 v78, 16, v155
    v_and_b32 v79, 0xffff0000, v155
    buffer_load_dwordx4 v[152:155], v19, s[12:15], 0 offen offset:0
    v_pk_fma_f32 v[98:99], v[82:83], v[78:79], v[98:99]
    v_lshlrev_b32_e64 v76, 16, v158
    v_and_b32 v77, 0xffff0000, v158
    v_pk_fma_f32 v[104:105], v[80:81], v[76:77], v[104:105]
    v_lshlrev_b32_e64 v78, 16, v159
    v_and_b32 v79, 0xffff0000, v159
    buffer_load_dwordx4 v[156:159], v19, s[12:15], 0 offen offset:256
    v_pk_fma_f32 v[106:107], v[82:83], v[78:79], v[106:107]
    v_lshlrev_b32_e64 v76, 16, v162
    v_and_b32 v77, 0xffff0000, v162
    v_pk_fma_f32 v[112:113], v[80:81], v[76:77], v[112:113]
    v_lshlrev_b32_e64 v78, 16, v163
    v_and_b32 v79, 0xffff0000, v163
    buffer_load_dwordx4 v[160:163], v19, s[12:15], 0 offen offset:512
    v_pk_fma_f32 v[114:115], v[82:83], v[78:79], v[114:115]
    s_nop 0
    s_setpc_b64 s[60:61]
K2_CTB:
    s_cmp_lg_u32 s36, 0
    s_cbranch_scc1 K2_CFBT
    v_lshlrev_b32_e64 v76, 16, v144
    v_and_b32 v77, 0xffff0000, v144
    v_pk_mul_f32 v[80:81], v[76:77], v[48:49]
    v_lshlrev_b32_e64 v78, 16, v145
    v_and_b32 v79, 0xffff0000, v145
    v_pk_mul_f32 v[82:83], v[78:79], v[50:51]
    v_lshlrev_b32_e64 v76, 16, v140
    v_and_b32 v77, 0xffff0000, v140
    v_pk_fma_f32 v[84:85], v[76:77], v[44:45], v[84:85]
    v_lshlrev_b32_e64 v78, 16, v141
    v_and_b32 v79, 0xffff0000, v141
    v_pk_fma_f32 v[86:87], v[78:79], v[46:47], v[86:87]
    s_waitcnt lgkmcnt(0)
    v_mfma_f32_16x16x32_bf16 v[56:59], v[24:27], v[32:35], 0
    v_mfma_f32_16x16x32_bf16 v[60:63], v[24:27], v[36:39], 0
    v_mfma_f32_16x16x32_bf16 v[64:67], v[24:27], v[40:43], 0
    v_mov_b32_e64 v32, v29
    v_lshlrev_b32_e64 v76, 16, v148
    v_and_b32 v77, 0xffff0000, v148
    v_pk_mul_f32 v[76:77], v[76:77], v[52:53]
    v_pk_fma_f32 v[92:93], v[76:77], v[28:29], v[92:93] op_sel:[0,0,0] op_sel_hi:[1,0,1]
    v_pk_fma_f32 v[100:101], v[76:77], v[32:33], v[100:101] op_sel:[0,0,0] op_sel_hi:[1,0,1]
    v_pk_fma_f32 v[108:109], v[76:77], v[30:31], v[108:109] op_sel:[0,0,0] op_sel_hi:[1,0,1]
    v_lshlrev_b32_e64 v78, 16, v149
    v_and_b32 v79, 0xffff0000, v149
    v_pk_mul_f32 v[78:79], v[78:79], v[54:55]
    v_pk_fma_f32 v[94:95], v[78:79], v[28:29], v[94:95] op_sel:[0,0,0] op_sel_hi:[1,0,1]
    v_pk_fma_f32 v[102:103], v[78:79], v[32:33], v[102:103] op_sel:[0,0,0] op_sel_hi:[1,0,1]
    v_pk_fma_f32 v[110:111], v[78:79], v[30:31], v[110:111] op_sel:[0,0,0] op_sel_hi:[1,0,1]
    v_lshlrev_b32_e64 v76, 16, v152
    v_and_b32 v77, 0xffff0000, v152
    v_pk_fma_f32 v[92:93], v[80:81], v[76:77], v[92:93]
    v_lshlrev_b32_e64 v78, 16, v153
    v_and_b32 v79, 0xffff0000, v153
    v_pk_fma_f32 v[94:95], v[82:83], v[78:79], v[94:95]
    v_lshlrev_b32_e64 v76, 16, v156
    v_and_b32 v77, 0xffff0000, v156
    v_pk_fma_f32 v[100:101], v[80:81], v[76:77], v[100:101]
    v_lshlrev_b32_e64 v78, 16, v157
    v_and_b32 v79, 0xffff0000, v157
    v_pk_fma_f32 v[102:103], v[82:83], v[78:79], v[102:103]
    v_lshlrev_b32_e64 v76, 16, v160
    v_and_b32 v77, 0xffff0000, v160
    v_pk_fma_f32 v[108:109], v[80:81], v[76:77], v[108:109]
    v_lshlrev_b32_e64 v78, 16, v161
    v_and_b32 v79, 0xffff0000, v161
    v_pk_fma_f32 v[110:111], v[82:83], v[78:79], v[110:111]
    v_lshlrev_b32_e64 v76, 16, v146
    v_and_b32 v77, 0xffff0000, v146
    v_pk_mul_f32 v[80:81], v[76:77], v[60:61]
    v_lshlrev_b32_e64 v78, 16, v147
    v_and_b32 v79, 0xffff0000, v147
    v_pk_mul_f32 v[82:83], v[78:79], v[62:63]
    v_lshlrev_b32_e64 v76, 16, v142
    v_and_b32 v77, 0xffff0000, v142
    v_pk_fma_f32 v[88:89], v[76:77], v[56:57], v[88:89]
    v_lshlrev_b32_e64 v78, 16, v143
    v_and_b32 v79, 0xffff0000, v143
    v_pk_fma_f32 v[90:91], v[78:79], v[58:59], v[90:91]
    v_lshlrev_b32_e64 v76, 16, v150
    v_and_b32 v77, 0xffff0000, v150
    v_pk_mul_f32 v[76:77], v[76:77], v[64:65]
    v_pk_fma_f32 v[96:97], v[76:77], v[28:29], v[96:97] op_sel:[0,0,0] op_sel_hi:[1,0,1]
    v_pk_fma_f32 v[104:105], v[76:77], v[32:33], v[104:105] op_sel:[0,0,0] op_sel_hi:[1,0,1]
    v_pk_fma_f32 v[112:113], v[76:77], v[30:31], v[112:113] op_sel:[0,0,0] op_sel_hi:[1,0,1]
    v_lshlrev_b32_e64 v78, 16, v151
    v_and_b32 v79, 0xffff0000, v151
    v_pk_mul_f32 v[78:79], v[78:79], v[66:67]
    v_pk_fma_f32 v[98:99], v[78:79], v[28:29], v[98:99] op_sel:[0,0,0] op_sel_hi:[1,0,1]
    v_pk_fma_f32 v[106:107], v[78:79], v[32:33], v[106:107] op_sel:[0,0,0] op_sel_hi:[1,0,1]
    v_pk_fma_f32 v[114:115], v[78:79], v[30:31], v[114:115] op_sel:[0,0,0] op_sel_hi:[1,0,1]
    ds_bpermute_b32 v15, v5, v20
    ds_bpermute_b32 v31, v10, v20
    ds_read_b96 v[28:30], v20 offset:13840
    ds_read_b128 v[32:35], v6 offset:7680
    ds_read_b128 v[36:39], v6 offset:8704
    ds_read_b128 v[40:43], v6 offset:9728
    v_lshlrev_b32_e64 v76, 16, v154
    v_and_b32 v77, 0xffff0000, v154
    v_pk_fma_f32 v[96:97], v[80:81], v[76:77], v[96:97]
    v_lshlrev_b32_e64 v78, 16, v155
    v_and_b32 v79, 0xffff0000, v155
    v_pk_fma_f32 v[98:99], v[82:83], v[78:79], v[98:99]
    v_lshlrev_b32_e64 v76, 16, v158
    v_and_b32 v77, 0xffff0000, v158
    v_pk_fma_f32 v[104:105], v[80:81], v[76:77], v[104:105]
    v_lshlrev_b32_e64 v78, 16, v159
    v_and_b32 v79, 0xffff0000, v159
    v_pk_fma_f32 v[106:107], v[82:83], v[78:79], v[106:107]
    v_lshlrev_b32_e64 v76, 16, v162
    v_and_b32 v77, 0xffff0000, v162
    v_pk_fma_f32 v[112:113], v[80:81], v[76:77], v[112:113]
    v_lshlrev_b32_e64 v78, 16, v163
    v_and_b32 v79, 0xffff0000, v163
    v_pk_fma_f32 v[114:115], v[82:83], v[78:79], v[114:115]
    s_waitcnt vmcnt(0)
    s_setpc_b64 s[60:61]
K2_CFBT:
    v_lshlrev_b32_e64 v76, 16, v144
    v_and_b32 v77, 0xffff0000, v144
    v_pk_mul_f32 v[80:81], v[76:77], v[48:49]
    v_lshlrev_b32_e64 v78, 16, v145
    v_and_b32 v79, 0xffff0000, v145
    v_pk_mul_f32 v[82:83], v[78:79], v[50:51]
    v_lshlrev_b32_e64 v76, 16, v140
    v_and_b32 v77, 0xffff0000, v140
    v_pk_mul_f32 v[84:85], v[76:77], v[44:45]
    v_lshlrev_b32_e64 v78, 16, v141
    v_and_b32 v79, 0xffff0000, v141
    v_pk_mul_f32 v[86:87], v[78:79], v[46:47]
    s_waitcnt lgkmcnt(0)
    v_mfma_f32_16x16x32_bf16 v[56:59], v[24:27], v[32:35], 0
    v_mfma_f32_16x16x32_bf16 v[60:63], v[24:27], v[36:39], 0
    v_mfma_f32_16x16x32_bf16 v[64:67], v[24:27], v[40:43], 0
    v_mov_b32_e64 v32, v29
    v_lshlrev_b32_e64 v76, 16, v148
    v_and_b32 v77, 0xffff0000, v148
    v_pk_mul_f32 v[76:77], v[76:77], v[52:53]
    v_pk_mul_f32 v[92:93], v[76:77], v[28:29] op_sel:[0,0] op_sel_hi:[1,0]
    v_pk_mul_f32 v[100:101], v[76:77], v[32:33] op_sel:[0,0] op_sel_hi:[1,0]
    v_pk_mul_f32 v[108:109], v[76:77], v[30:31] op_sel:[0,0] op_sel_hi:[1,0]
    v_lshlrev_b32_e64 v78, 16, v149
    v_and_b32 v79, 0xffff0000, v149
    v_pk_mul_f32 v[78:79], v[78:79], v[54:55]
    v_pk_mul_f32 v[94:95], v[78:79], v[28:29] op_sel:[0,0] op_sel_hi:[1,0]
    v_pk_mul_f32 v[102:103], v[78:79], v[32:33] op_sel:[0,0] op_sel_hi:[1,0]
    v_pk_mul_f32 v[110:111], v[78:79], v[30:31] op_sel:[0,0] op_sel_hi:[1,0]
    v_lshlrev_b32_e64 v76, 16, v152
    v_and_b32 v77, 0xffff0000, v152
    v_pk_fma_f32 v[92:93], v[80:81], v[76:77], v[92:93]
    v_lshlrev_b32_e64 v78, 16, v153
    v_and_b32 v79, 0xffff0000, v153
    v_pk_fma_f32 v[94:95], v[82:83], v[78:79], v[94:95]
    v_lshlrev_b32_e64 v76, 16, v156
    v_and_b32 v77, 0xffff0000, v156
    v_pk_fma_f32 v[100:101], v[80:81], v[76:77], v[100:101]
    v_lshlrev_b32_e64 v78, 16, v157
    v_and_b32 v79, 0xffff0000, v157
    v_pk_fma_f32 v[102:103], v[82:83], v[78:79], v[102:103]
    v_lshlrev_b32_e64 v76, 16, v160
    v_and_b32 v77, 0xffff0000, v160
    v_pk_fma_f32 v[108:109], v[80:81], v[76:77], v[108:109]
    v_lshlrev_b32_e64 v78, 16, v161
    v_and_b32 v79, 0xffff0000, v161
    v_pk_fma_f32 v[110:111], v[82:83], v[78:79], v[110:111]
    v_lshlrev_b32_e64 v76, 16, v146
    v_and_b32 v77, 0xffff0000, v146
    v_pk_mul_f32 v[80:81], v[76:77], v[60:61]
    v_lshlrev_b32_e64 v78, 16, v147
    v_and_b32 v79, 0xffff0000, v147
    v_pk_mul_f32 v[82:83], v[78:79], v[62:63]
    v_lshlrev_b32_e64 v76, 16, v142
    v_and_b32 v77, 0xffff0000, v142
    v_pk_mul_f32 v[88:89], v[76:77], v[56:57]
    v_lshlrev_b32_e64 v78, 16, v143
    v_and_b32 v79, 0xffff0000, v143
    v_pk_mul_f32 v[90:91], v[78:79], v[58:59]
    v_lshlrev_b32_e64 v76, 16, v150
    v_and_b32 v77, 0xffff0000, v150
    v_pk_mul_f32 v[76:77], v[76:77], v[64:65]
    v_pk_mul_f32 v[96:97], v[76:77], v[28:29] op_sel:[0,0] op_sel_hi:[1,0]
    v_pk_mul_f32 v[104:105], v[76:77], v[32:33] op_sel:[0,0] op_sel_hi:[1,0]
    v_pk_mul_f32 v[112:113], v[76:77], v[30:31] op_sel:[0,0] op_sel_hi:[1,0]
    v_lshlrev_b32_e64 v78, 16, v151
    v_and_b32 v79, 0xffff0000, v151
    v_pk_mul_f32 v[78:79], v[78:79], v[66:67]
    v_pk_mul_f32 v[98:99], v[78:79], v[28:29] op_sel:[0,0] op_sel_hi:[1,0]
    v_pk_mul_f32 v[106:107], v[78:79], v[32:33] op_sel:[0,0] op_sel_hi:[1,0]
    v_pk_mul_f32 v[114:115], v[78:79], v[30:31] op_sel:[0,0] op_sel_hi:[1,0]
    ds_bpermute_b32 v15, v5, v20
    ds_bpermute_b32 v31, v10, v20
    ds_read_b96 v[28:30], v20 offset:13840
    ds_read_b128 v[32:35], v6 offset:7680
    ds_read_b128 v[36:39], v6 offset:8704
    ds_read_b128 v[40:43], v6 offset:9728
    v_lshlrev_b32_e64 v76, 16, v154
    v_and_b32 v77, 0xffff0000, v154
    v_pk_fma_f32 v[96:97], v[80:81], v[76:77], v[96:97]
    v_lshlrev_b32_e64 v78, 16, v155
    v_and_b32 v79, 0xffff0000, v155
    v_pk_fma_f32 v[98:99], v[82:83], v[78:79], v[98:99]
    v_lshlrev_b32_e64 v76, 16, v158
    v_and_b32 v77, 0xffff0000, v158
    v_pk_fma_f32 v[104:105], v[80:81], v[76:77], v[104:105]
    v_lshlrev_b32_e64 v78, 16, v159
    v_and_b32 v79, 0xffff0000, v159
    v_pk_fma_f32 v[106:107], v[82:83], v[78:79], v[106:107]
    v_lshlrev_b32_e64 v76, 16, v162
    v_and_b32 v77, 0xffff0000, v162
    v_pk_fma_f32 v[112:113], v[80:81], v[76:77], v[112:113]
    v_lshlrev_b32_e64 v78, 16, v163
    v_and_b32 v79, 0xffff0000, v163
    v_pk_fma_f32 v[114:115], v[82:83], v[78:79], v[114:115]
    s_waitcnt vmcnt(0)
    s_setpc_b64 s[60:61]
K2_EPI:
    s_waitcnt vmcnt(6)
    v_add_f32_dpp v78, v84, v84 row_ror:8 row_mask:0xf bank_mask:0x3
    v_add_f32_dpp v79, v85, v85 row_ror:8 row_mask:0xf bank_mask:0x3
    v_lshlrev_b32_e64 v76, 16, v68
    v_add_f32_dpp v78, v92, v92 row_ror:8 row_mask:0xf bank_mask:0xc
    v_add_f32_dpp v79, v93, v93 row_ror:8 row_mask:0xf bank_mask:0xc
    v_and_b32 v77, 0xffff0000, v68
    v_add_f32_e64 v76, v76, v78
    v_add_f32_e64 v77, v77, v79
    v_cvt_pk_bf16_f32 v44, v76, v77
    v_add_f32_dpp v78, v86, v86 row_ror:8 row_mask:0xf bank_mask:0x3
    v_add_f32_dpp v79, v87, v87 row_ror:8 row_mask:0xf bank_mask:0x3
    v_lshlrev_b32_e64 v76, 16, v69
    v_add_f32_dpp v78, v94, v94 row_ror:8 row_mask:0xf bank_mask:0xc
    v_add_f32_dpp v79, v95, v95 row_ror:8 row_mask:0xf bank_mask:0xc
    v_and_b32 v77, 0xffff0000, v69
    v_add_f32_e64 v76, v76, v78
    v_add_f32_e64 v77, v77, v79
    v_cvt_pk_bf16_f32 v45, v76, v77
    v_add_f32_dpp v78, v88, v88 row_ror:8 row_mask:0xf bank_mask:0x3
    v_add_f32_dpp v79, v89, v89 row_ror:8 row_mask:0xf bank_mask:0x3
    v_lshlrev_b32_e64 v76, 16, v70
    v_add_f32_dpp v78, v96, v96 row_ror:8 row_mask:0xf bank_mask:0xc
    v_add_f32_dpp v79, v97, v97 row_ror:8 row_mask:0xf bank_mask:0xc
    v_and_b32 v77, 0xffff0000, v70
    v_add_f32_e64 v76, v76, v78
    v_add_f32_e64 v77, v77, v79
    v_cvt_pk_bf16_f32 v46, v76, v77
    v_add_f32_dpp v78, v90, v90 row_ror:8 row_mask:0xf bank_mask:0x3
    v_add_f32_dpp v79, v91, v91 row_ror:8 row_mask:0xf bank_mask:0x3
    v_lshlrev_b32_e64 v76, 16, v71
    v_add_f32_dpp v78, v98, v98 row_ror:8 row_mask:0xf bank_mask:0xc
    v_add_f32_dpp v79, v99, v99 row_ror:8 row_mask:0xf bank_mask:0xc
    v_and_b32 v77, 0xffff0000, v71
    v_add_f32_e64 v76, v76, v78
    v_add_f32_e64 v77, v77, v79
    v_cvt_pk_bf16_f32 v47, v76, v77
    v_add_f32_dpp v78, v100, v100 row_ror:8 row_mask:0xf bank_mask:0x3
    v_add_f32_dpp v79, v101, v101 row_ror:8 row_mask:0xf bank_mask:0x3
    v_lshlrev_b32_e64 v76, 16, v72
    v_add_f32_dpp v78, v108, v108 row_ror:8 row_mask:0xf bank_mask:0xc
    v_add_f32_dpp v79, v109, v109 row_ror:8 row_mask:0xf bank_mask:0xc
    v_and_b32 v77, 0xffff0000, v72
    v_add_f32_e64 v76, v76, v78
    v_add_f32_e64 v77, v77, v79
    v_cvt_pk_bf16_f32 v48, v76, v77
    v_add_f32_dpp v78, v102, v102 row_ror:8 row_mask:0xf bank_mask:0x3
    v_add_f32_dpp v79, v103, v103 row_ror:8 row_mask:0xf bank_mask:0x3
    v_lshlrev_b32_e64 v76, 16, v73
    v_add_f32_dpp v78, v110, v110 row_ror:8 row_mask:0xf bank_mask:0xc
    v_add_f32_dpp v79, v111, v111 row_ror:8 row_mask:0xf bank_mask:0xc
    v_and_b32 v77, 0xffff0000, v73
    v_add_f32_e64 v76, v76, v78
    v_add_f32_e64 v77, v77, v79
    v_cvt_pk_bf16_f32 v49, v76, v77
    v_add_f32_dpp v78, v104, v104 row_ror:8 row_mask:0xf bank_mask:0x3
    v_add_f32_dpp v79, v105, v105 row_ror:8 row_mask:0xf bank_mask:0x3
    v_lshlrev_b32_e64 v76, 16, v74
    v_add_f32_dpp v78, v112, v112 row_ror:8 row_mask:0xf bank_mask:0xc
    v_add_f32_dpp v79, v113, v113 row_ror:8 row_mask:0xf bank_mask:0xc
    v_and_b32 v77, 0xffff0000, v74
    v_add_f32_e64 v76, v76, v78
    v_add_f32_e64 v77, v77, v79
    v_cvt_pk_bf16_f32 v50, v76, v77
    v_add_f32_dpp v78, v106, v106 row_ror:8 row_mask:0xf bank_mask:0x3
    v_add_f32_dpp v79, v107, v107 row_ror:8 row_mask:0xf bank_mask:0x3
    v_lshlrev_b32_e64 v76, 16, v75
    v_add_f32_dpp v78, v114, v114 row_ror:8 row_mask:0xf bank_mask:0xc
    v_add_f32_dpp v79, v115, v115 row_ror:8 row_mask:0xf bank_mask:0xc
    v_and_b32 v77, 0xffff0000, v75
    v_add_f32_e64 v76, v76, v78
    v_add_f32_e64 v77, v77, v79
    v_cvt_pk_bf16_f32 v51, v76, v77
    s_nop 0
    s_setpc_b64 s[60:61]
K2_EPH:
    s_waitcnt vmcnt(6)
    v_permlane16_swap_b32 v84, v100
    v_permlane16_swap_b32 v92, v108
    v_permlane16_swap_b32 v85, v101
    v_permlane16_swap_b32 v93, v109
    v_add_f32_e64 v84, v84, v100
    v_add_f32_e64 v92, v92, v108
    v_add_f32_e64 v85, v85, v101
    v_add_f32_e64 v93, v93, v109
    v_lshlrev_b32_e64 v76, 16, v68
    v_and_b32 v77, 0xffff0000, v68
    v_add_f32_dpp v100, v84, v84 row_ror:8 row_mask:0xf bank_mask:0x3
    v_add_f32_dpp v101, v85, v85 row_ror:8 row_mask:0xf bank_mask:0x3
    v_add_f32_dpp v100, v92, v92 row_ror:8 row_mask:0xf bank_mask:0xc
    v_add_f32_dpp v101, v93, v93 row_ror:8 row_mask:0xf bank_mask:0xc
    v_add_f32_e64 v76, v76, v100
    v_add_f32_e64 v77, v77, v101
    v_cvt_pk_bf16_f32 v44, v76, v77
    v_permlane16_swap_b32 v86, v102
    v_permlane16_swap_b32 v94, v110
    v_permlane16_swap_b32 v87, v103
    v_permlane16_swap_b32 v95, v111
    v_add_f32_e64 v86, v86, v102
    v_add_f32_e64 v94, v94, v110
    v_add_f32_e64 v87, v87, v103
    v_add_f32_e64 v95, v95, v111
    v_lshlrev_b32_e64 v76, 16, v69
    v_and_b32 v77, 0xffff0000, v69
    v_add_f32_dpp v102, v86, v86 row_ror:8 row_mask:0xf bank_mask:0x3
    v_add_f32_dpp v103, v87, v87 row_ror:8 row_mask:0xf bank_mask:0x3
    v_add_f32_dpp v102, v94, v94 row_ror:8 row_mask:0xf bank_mask:0xc
    v_add_f32_dpp v103, v95, v95 row_ror:8 row_mask:0xf bank_mask:0xc
    v_add_f32_e64 v76, v76, v102
    v_add_f32_e64 v77, v77, v103
    v_cvt_pk_bf16_f32 v45, v76, v77
    v_permlane16_swap_b32 v88, v104
    v_permlane16_swap_b32 v96, v112
    v_permlane16_swap_b32 v89, v105
    v_permlane16_swap_b32 v97, v113
    v_add_f32_e64 v88, v88, v104
    v_add_f32_e64 v96, v96, v112
    v_add_f32_e64 v89, v89, v105
    v_add_f32_e64 v97, v97, v113
    v_lshlrev_b32_e64 v76, 16, v70
    v_and_b32 v77, 0xffff0000, v70
    v_add_f32_dpp v104, v88, v88 row_ror:8 row_mask:0xf bank_mask:0x3
    v_add_f32_dpp v105, v89, v89 row_ror:8 row_mask:0xf bank_mask:0x3
    v_add_f32_dpp v104, v96, v96 row_ror:8 row_mask:0xf bank_mask:0xc
    v_add_f32_dpp v105, v97, v97 row_ror:8 row_mask:0xf bank_mask:0xc
    v_add_f32_e64 v76, v76, v104
    v_add_f32_e64 v77, v77, v105
    v_cvt_pk_bf16_f32 v46, v76, v77
    v_permlane16_swap_b32 v90, v106
    v_permlane16_swap_b32 v98, v114
    v_permlane16_swap_b32 v91, v107
    v_permlane16_swap_b32 v99, v115
    v_add_f32_e64 v90, v90, v106
    v_add_f32_e64 v98, v98, v114
    v_add_f32_e64 v91, v91, v107
    v_add_f32_e64 v99, v99, v115
    v_lshlrev_b32_e64 v76, 16, v71
    v_and_b32 v77, 0xffff0000, v71
    v_add_f32_dpp v106, v90, v90 row_ror:8 row_mask:0xf bank_mask:0x3
    v_add_f32_dpp v107, v91, v91 row_ror:8 row_mask:0xf bank_mask:0x3
    v_add_f32_dpp v106, v98, v98 row_ror:8 row_mask:0xf bank_mask:0xc
    v_add_f32_dpp v107, v99, v99 row_ror:8 row_mask:0xf bank_mask:0xc
    v_add_f32_e64 v76, v76, v106
    v_add_f32_e64 v77, v77, v107
    v_cvt_pk_bf16_f32 v47, v76, v77
    s_nop 0
    s_setpc_b64 s[60:61]
K2_GEOM:
    v_and_b32 v46, 1, v32
    v_lshlrev_b32 v46, 4, v46
    v_alignbit_b32 v41, v37, v36, v46
    v_lshrrev_b32 v42, v46, v37
    v_lshlrev_b32 v40, 16, v41
    v_and_b32 v41, 0xffff0000, v41
    v_lshlrev_b32 v42, 16, v42
    v_and_b32 v47, 1, v33
    v_lshlrev_b32 v47, 4, v47
    v_alignbit_b32 v44, v39, v38, v47
    v_lshrrev_b32 v45, v47, v39
    v_lshlrev_b32 v43, 16, v44
    v_and_b32 v44, 0xffff0000, v44
    v_lshlrev_b32 v45, 16, v45
    v_sub_f32 v40, v40, v43
    v_sub_f32 v41, v41, v44
    v_sub_f32 v42, v42, v45
    v_cvt_pk_bf16_f32 v40, v40, v41
    v_and_b32 v41, 0xffff0000, v40
    v_lshlrev_b32 v40, 16, v40
    v_cvt_pk_bf16_f32 v42, v42, v42
    v_and_b32 v42, 0xffff0000, v42
    v_mul_f32 v43, v40, v40
    v_mul_f32 v44, v41, v41
    v_mul_f32 v45, v42, v42
    v_cvt_pk_bf16_f32 v43, v43, v44
    v_and_b32 v44, 0xffff0000, v43
    v_lshlrev_b32 v43, 16, v43
    v_cvt_pk_bf16_f32 v45, v45, v45
    v_and_b32 v45, 0xffff0000, v45
    v_add_f32 v43, v43, v44
    v_add_f32 v43, v43, v45
    v_cvt_pk_bf16_f32 v43, v43, v43
    v_and_b32 v43, 0xffff0000, v43
    v_add_f32 v43, 0x322bcc77, v43
    v_cvt_pk_bf16_f32 v43, v43, v43
    v_and_b32 v43, 0xffff0000, v43
    v_sqrt_f32 v43, v43
    s_nop 0
    v_cvt_pk_bf16_f32 v43, v43, v43
    v_and_b32 v43, 0xffff0000, v43
    v_rcp_f32 v44, v43
    v_mul_f32 v45, s64, v43
    v_mul_f32 v46, s65, v43
    v_mul_f32 v47, s66, v43
    v_mul_f32 v48, s67, v43
    v_mul_f32 v49, 0x40490fdb, v43
    v_mul_f32 v40, v40, v44
    v_mul_f32 v41, v41, v44
    v_mul_f32 v42, v42, v44
    v_cvt_pk_bf16_f32 v40, v40, v41
    v_and_b32 v41, 0xffff0000, v40
    v_lshlrev_b32 v40, 16, v40
    v_cvt_pk_bf16_f32 v42, v42, v42
    v_and_b32 v42, 0xffff0000, v42
    v_cvt_pk_bf16_f32 v45, v45, v46
    v_and_b32 v46, 0xffff0000, v45
    v_lshlrev_b32 v45, 16, v45
    v_cvt_pk_bf16_f32 v47, v47, v48
    v_and_b32 v48, 0xffff0000, v47
    v_lshlrev_b32 v47, 16, v47
    v_cvt_pk_bf16_f32 v49, v49, v49
    v_and_b32 v49, 0xffff0000, v49
    v_mul_f32 v45, 0.15915494, v45
    v_mul_f32 v46, 0.15915494, v46
    v_mul_f32 v47, 0.15915494, v47
    v_mul_f32 v48, 0.15915494, v48
    v_mul_f32 v49, 0x3e4ccccd, v49
    v_sin_f32 v45, v45
    v_sin_f32 v46, v46
    v_sin_f32 v47, v47
    v_sin_f32 v48, v48
    v_cvt_pk_bf16_f32 v49, v49, v49
    v_and_b32 v49, 0xffff0000, v49
    v_mul_f32 v49, 0.15915494, v49
    v_cos_f32 v49, v49
    v_cvt_pk_bf16_f32 v45, v45, v46
    v_and_b32 v46, 0xffff0000, v45
    v_lshlrev_b32 v45, 16, v45
    v_cvt_pk_bf16_f32 v47, v47, v48
    v_and_b32 v48, 0xffff0000, v47
    v_lshlrev_b32 v47, 16, v47
    v_cvt_pk_bf16_f32 v49, v49, v49
    v_and_b32 v49, 0xffff0000, v49
    v_mul_f32 v45, v45, v44
    v_mul_f32 v46, v46, v44
    v_mul_f32 v47, v47, v44
    v_mul_f32 v48, v48, v44
    v_add_f32 v49, 1.0, v49
    v_cvt_pk_bf16_f32 v45, v45, v46
    v_and_b32 v46, 0xffff0000, v45
    v_lshlrev_b32 v45, 16, v45
    v_cvt_pk_bf16_f32 v47, v47, v48
    v_and_b32 v48, 0xffff0000, v47
    v_lshlrev_b32 v47, 16, v47
    v_cvt_pk_bf16_f32 v49, v49, v49
    v_and_b32 v49, 0xffff0000, v49
    v_mul_f32 v49, 0.5, v49
    v_mul_f32 v50, 0, v43
    v_cmp_gt_f32 vcc, 0x40a00000, v43
    s_nop 0
    s_mov_b64 s[72:73], vcc
    v_cndmask_b32 v49, v50, v49, s[72:73]
    v_mul_f32 v45, v45, v49
    v_mul_f32 v46, v46, v49
    v_mul_f32 v47, v47, v49
    v_mul_f32 v48, v48, v49
    v_cvt_pk_bf16_f32 v54, v45, v46
    v_cvt_pk_bf16_f32 v55, v47, v48
    ds_write_b64 v34, v[54:55] offset:13824
    ds_write_b128 v34, v[40:43] offset:13840
    s_setpc_b64 s[68:69]
K2_SLOW:
    v_mov_b32 v76, 0
K2_SLW:
    ds_read_b32 v77, v76 offset:1288
    s_waitcnt lgkmcnt(0)
    v_readfirstlane_b32 s57, v77
    s_nop 0
    s_cmp_lt_u32 s57, 10
    s_nop 1
    s_cbranch_scc1 K2_SLW
    s_mov_b32 s36, 0
    s_mov_b32 s37, 0
    s_mov_b32 s44, 0
    s_mov_b32 s45, 0
    s_add_u32 s32, s10, 0xa10000
    s_addc_u32 s33, s11, 0
    s_mov_b32 s34, 0x13e000
    s_mov_b32 s35, 0x20000
    s_add_u32 s10, s10, 0xa00000
    s_addc_u32 s11, s11, 0
    s_mul_i32 s40, s43, 1088
K2_SNODE:
    s_cmp_lt_i32 s52, 0
    s_cbranch_scc1 K2_DONE
    s_waitcnt lgkmcnt(0)
    s_mov_b32 s7, s6
    v_add_u32 v12, s42, v13
    v_cmp_gt_u32 vcc, 313, v13
    s_nop 0
    s_mov_b64 s[72:73], vcc
    s_cmp_lg_u32 s6, 0
    s_cselect_b32 s8, 16, 8
    s_cbranch_scc1 K2_PSHS
    v_lshl_add_u32 v11, v13, 7, v4
    v_lshl_add_u32 v12, v12, 10, v3
    s_nop 0
    s_branch K2_PSES
K2_PSHS:
    v_lshlrev_b32 v17, 2, v13
    ds_read_b32 v17, v17 offset:0
    v_lshl_add_u32 v11, v13, 7, v167
    v_lshl_add_u32 v12, v12, 10, v166
    s_waitcnt lgkmcnt(0)
    v_readlane_b32 s51, v17, 0
    v_readlane_b32 s57, v17, 32
    s_nop 0
    s_max_u32 s51, s51, s57
    s_add_u32 s51, s51, 3
    s_lshr_b32 s51, s51, 2
    s_max_u32 s51, s51, 3
    s_min_u32 s51, s51, 8
K2_PSES:
    v_cndmask_b32 v12, v9, v12, s[72:73]
    v_add_u32 v76, s42, v13
    v_cndmask_b32 v76, -1, v76, s[72:73]
    s_nop 0
    v_readlane_b32 s54, v76, 0
    v_readlane_b32 s55, v76, 16
    v_readlane_b32 s4, v76, 32
    v_readlane_b32 s5, v76, 48
    v_mov_b32 v84, 0
    v_mov_b32 v85, 0
    v_mov_b32 v86, 0
    v_mov_b32 v87, 0
    v_mov_b32 v88, 0
    v_mov_b32 v89, 0
    v_mov_b32 v90, 0
    v_mov_b32 v91, 0
    v_mov_b32 v92, 0
    v_mov_b32 v93, 0
    v_mov_b32 v94, 0
    v_mov_b32 v95, 0
    v_mov_b32 v96, 0
    v_mov_b32 v97, 0
    v_mov_b32 v98, 0
    v_mov_b32 v99, 0
    v_mov_b32 v100, 0
    v_mov_b32 v101, 0
    v_mov_b32 v102, 0
    v_mov_b32 v103, 0
    v_mov_b32 v104, 0
    v_mov_b32 v105, 0
    v_mov_b32 v106, 0
    v_mov_b32 v107, 0
    v_mov_b32 v108, 0
    v_mov_b32 v109, 0
    v_mov_b32 v110, 0
    v_mov_b32 v111, 0
    v_mov_b32 v112, 0
    v_mov_b32 v113, 0
    v_mov_b32 v114, 0
    v_mov_b32 v115, 0
    v_mov_b32 v165, 0
    s_mov_b64 exec, 1
    ds_add_rtn_u32 v165, v165, v7 offset:1300
    s_mov_b64 exec, -1
    s_waitcnt lgkmcnt(0)
    v_readfirstlane_b32 s50, v165
    s_nop 0
    s_add_u32 s50, s50, s75
    s_cmp_lt_u32 s50, s9
    s_cselect_b32 s6, 1, 0
    s_cbranch_scc1 K2_NPHS
    s_sub_u32 s57, s50, s9
    s_lshl_b32 s57, s57, 2
    s_min_u32 s57, s57, 500
    v_cmp_ge_u32 vcc, s57, v14
    s_nop 0
    s_bcnt1_i32_b64 s72, vcc
    s_sub_u32 s52, 6, s72
    s_add_u32 s57, s57, 512
    v_lshl_add_u32 v13, s57, 1, v8
    s_nop 0
    s_branch K2_NPES
K2_NPHS:
    s_lshl_b32 s57, s50, 2
    s_mov_b32 s52, 1
    v_add_u32 v13, s57, v164
K2_NPES:
    ds_read_u16 v13, v13 offset:1536
    s_mov_b32 s41, 0
K2_SC:
    v_add_u32 v76, s41, v0
    v_lshrrev_b32 v77, 5, v76
    v_lshlrev_b32 v77, 7, v77
    v_add_u32 v77, s48, v77
    v_and_b32 v78, 31, v76
    v_lshl_add_u32 v77, v77, 5, v78
    v_lshlrev_b32 v78, 2, v77
    buffer_load_dword v79, v78, s[28:31], 0 offen
    s_movk_i32 s57, 1696
    v_cmp_gt_u32 s[58:59], s57, v76
    s_nop 3
    s_call_b64 s[70:71], K2_SMATCH
    s_add_u32 s41, s41, 64
    s_cmp_lt_u32 s41, 1696
    s_cbranch_scc1 K2_SC
    s_mov_b32 s56, 0
K2_SW:
    s_lshl_b32 s57, s56, 2
    s_load_dword s76, s[10:11], s57
    s_mul_i32 s46, s56, 6144
    s_waitcnt lgkmcnt(0)
    s_min_u32 s76, s76, 6144
    s_mov_b32 s41, 0
K2_SS:
    s_cmp_ge_u32 s41, s76
    s_cbranch_scc1 K2_SWN
    v_add_u32 v76, s41, v0
    v_add_u32 v77, s46, v76
    v_lshlrev_b32 v78, 2, v77
    buffer_load_dword v79, v78, s[32:35], 0 offen
    v_cmp_gt_u32 s[58:59], s76, v76
    s_nop 3
    s_call_b64 s[70:71], K2_SMATCH
    s_add_u32 s41, s41, 64
    s_branch K2_SS
K2_SWN:
    s_add_u32 s56, s56, 1
    s_cmp_lt_u32 s56, 53
    s_cbranch_scc1 K2_SW
    buffer_load_dwordx4 v[68:71], v12, s[12:15], 0 offen
    buffer_load_dwordx4 v[72:75], v12, s[12:15], 0 offen offset:512
    s_waitcnt vmcnt(0)
    s_call_b64 s[60:61], K2_EPI
    buffer_store_dwordx4 v[44:47], v12, s[24:27], 0 offen
    buffer_store_dwordx4 v[48:51], v12, s[24:27], 0 offen offset:512
    s_nop 0
    s_branch K2_SNODE
K2_SMATCH:
    s_waitcnt vmcnt(0)
    v_lshrrev_b32 v33, 14, v79
    s_mov_b64 s[78:79], 0
    v_cmp_eq_u32 vcc, s54, v33
    s_nop 0
    s_or_b64 s[78:79], s[78:79], vcc
    v_cmp_eq_u32 vcc, s55, v33
    s_nop 0
    s_or_b64 s[78:79], s[78:79], vcc
    v_cmp_eq_u32 vcc, s4, v33
    s_nop 0
    s_or_b64 s[78:79], s[78:79], vcc
    v_cmp_eq_u32 vcc, s5, v33
    s_nop 0
    s_or_b64 s[78:79], s[78:79], vcc
    s_and_b64 s[58:59], s[78:79], s[58:59]
    s_cmp_eq_u64 s[58:59], 0
    s_cbranch_scc1 K2_SMRET
    v_and_b32 v32, 0x3fff, v79
    s_mov_b64 exec, s[58:59]
    v_mul_u32_u24 v40, 6, v32
    v_mul_u32_u24 v41, 6, v33
    v_and_b32 v40, -4, v40
    v_and_b32 v41, -4, v41
    buffer_load_dwordx2 v[36:37], v40, s[20:23], 0 offen
    buffer_load_dwordx2 v[38:39], v41, s[20:23], 0 offen
    s_mov_b64 exec, -1
    v_mov_b32 v76, 0xffffff
    v_lshl_add_u32 v77, v0, 2, s40
    ds_write_b32 v77, v76 offset:46592
    ds_write_b32 v77, v76 offset:46848
    ds_write_b32 v77, v76 offset:47104
    ds_write_b32 v77, v76 offset:47360
    s_mov_b64 exec, 0xffff
    ds_write_b32 v77, v76 offset:47616
    s_mov_b64 exec, -1
    s_lshl_b32 s57, s43, 6
    v_add_u32 v34, s57, v0
    v_lshl_or_b32 v78, v34, 14, v32
    v_lshlrev_b32 v34, 5, v34
    s_mov_b32 s47, 0
    v_cmp_eq_u32 vcc, s54, v33
    s_nop 0
    s_and_b64 s[50:51], vcc, s[58:59]
    v_mbcnt_lo_u32_b32 v76, s50, 0
    v_mbcnt_hi_u32_b32 v76, s51, v76
    v_lshl_add_u32 v77, v76, 2, s40
    s_bcnt1_i32_b64 s57, s[50:51]
    s_max_u32 s47, s47, s57
    s_mov_b64 exec, s[50:51]
    ds_write_b32 v77, v78 offset:46592
    s_mov_b64 exec, -1
    v_cmp_eq_u32 vcc, s55, v33
    s_nop 0
    s_and_b64 s[50:51], vcc, s[58:59]
    v_mbcnt_lo_u32_b32 v76, s50, 0
    v_mbcnt_hi_u32_b32 v76, s51, v76
    v_lshl_add_u32 v77, v76, 2, s40
    s_bcnt1_i32_b64 s57, s[50:51]
    s_max_u32 s47, s47, s57
    s_mov_b64 exec, s[50:51]
    ds_write_b32 v77, v78 offset:46864
    s_mov_b64 exec, -1
    v_cmp_eq_u32 vcc, s4, v33
    s_nop 0
    s_and_b64 s[50:51], vcc, s[58:59]
    v_mbcnt_lo_u32_b32 v76, s50, 0
    v_mbcnt_hi_u32_b32 v76, s51, v76
    v_lshl_add_u32 v77, v76, 2, s40
    s_bcnt1_i32_b64 s57, s[50:51]
    s_max_u32 s47, s47, s57
    s_mov_b64 exec, s[50:51]
    ds_write_b32 v77, v78 offset:47136
    s_mov_b64 exec, -1
    v_cmp_eq_u32 vcc, s5, v33
    s_nop 0
    s_and_b64 s[50:51], vcc, s[58:59]
    v_mbcnt_lo_u32_b32 v76, s50, 0
    v_mbcnt_hi_u32_b32 v76, s51, v76
    v_lshl_add_u32 v77, v76, 2, s40
    s_bcnt1_i32_b64 s57, s[50:51]
    s_max_u32 s47, s47, s57
    s_mov_b64 exec, s[50:51]
    ds_write_b32 v77, v78 offset:47408
    s_mov_b64 exec, -1
    s_add_u32 s47, s47, 1
    s_lshr_b32 s47, s47, 1
    s_waitcnt vmcnt(0)
    s_mov_b64 exec, s[58:59]
    s_call_b64 s[68:69], K2_GEOM
    s_mov_b64 exec, -1
    v_mul_u32_u24 v11, 136, v8
    v_add_u32 v11, v11, v4
    v_add_u32 v11, s40, v11
K2_SML:
    ds_read_b32 v17, v11 offset:46592
    s_waitcnt lgkmcnt(0)
    v_and_b32 v19, 0x3fff, v17
    v_lshrrev_b32 v17, 14, v17
    v_mad_u32_u24 v18, v19, s74, v1
    v_lshl_add_u32 v19, v19, 10, v2
    v_lshlrev_b32 v20, 5, v17
    v_add_u32 v11, s8, v11
    buffer_load_dwordx4 v[116:119], v18, s[16:19], 0 offen offset:0
    buffer_load_dwordx4 v[120:123], v18, s[16:19], 0 offen offset:128
    buffer_load_dwordx4 v[124:127], v18, s[16:19], 0 offen offset:256
    buffer_load_dwordx4 v[128:131], v19, s[12:15], 0 offen offset:0
    buffer_load_dwordx4 v[132:135], v19, s[12:15], 0 offen offset:256
    buffer_load_dwordx4 v[136:139], v19, s[12:15], 0 offen offset:512
    ds_bpermute_b32 v15, v5, v20
    ds_bpermute_b32 v31, v10, v20
    ds_read_b96 v[28:30], v20 offset:13840
    ds_read_b128 v[32:35], v6 offset:7680
    ds_read_b128 v[36:39], v6 offset:8704
    ds_read_b128 v[40:43], v6 offset:9728
    s_waitcnt lgkmcnt(0)
    s_mov_b64 exec, s[38:39]
    ds_read_b64 v[24:25], v15 offset:13824
    ds_read_b64 v[26:27], v31 offset:13824
    s_mov_b64 exec, -1
    s_waitcnt vmcnt(0) lgkmcnt(0)
    s_call_b64 s[60:61], K2_CMP_A
    s_waitcnt lgkmcnt(0)
    s_sub_u32 s47, s47, 1
    s_cmp_lg_u32 s47, 0
    s_cbranch_scc1 K2_SML
K2_SMRET:
    s_setpc_b64 s[70:71]
K2_END:
    s_endpgm
.section .rodata,"a"
.p2align 6
.amdhsa_kernel painn_k1_kernel
  .amdhsa_next_free_vgpr 128
  .amdhsa_next_free_sgpr 80
  .amdhsa_accum_offset 128
  .amdhsa_group_segment_fixed_size 0
  .amdhsa_kernarg_size 88
  .amdhsa_user_sgpr_count 2
  .amdhsa_user_sgpr_kernarg_segment_ptr 1
  .amdhsa_system_sgpr_workgroup_id_x 1
.end_amdhsa_kernel
.p2align 6
.amdhsa_kernel painn_k2_kernel
  .amdhsa_next_free_vgpr 168
  .amdhsa_next_free_sgpr 80
  .amdhsa_accum_offset 168
  .amdhsa_group_segment_fixed_size 0
  .amdhsa_kernarg_size 88
  .amdhsa_user_sgpr_count 2
  .amdhsa_user_sgpr_kernarg_segment_ptr 1
  .amdhsa_system_sgpr_workgroup_id_x 1
.end_amdhsa_kernel
```
